```python
import torch

def _softmax(x, axis=-1):
    return torch.softmax(x, dim=axis)

def _gelu(x):
    return torch.nn.functional.gelu(x, approximate='tanh')

def _silu(x):
    return torch.nn.functional.silu(x)

def _sigmoid(x):
    return torch.sigmoid(x)

def _layernorm(x, axis=-1, eps=1e-05):
    m = x.mean(dim=axis, keepdim=True)
    v = x.var(dim=axis, keepdim=True, unbiased=False)
    return (x - m) / torch.sqrt(v + eps)

def _scatter_add(tgt, idx, src, axis=0):
    return tgt.clone().index_add_(axis, idx, src)

def _segment_sum(src, seg, n):
    out = torch.zeros((n,) + src.shape[1:], dtype=src.dtype)
    return out.index_add_(0, seg, src)

def _pad(x, pw):
    flat = tuple((v for pair in reversed(pw) for v in pair))
    return torch.nn.functional.pad(x, flat)
kernel_name = 'parallel_sum__ssm_conv_s4d__mixer_gmlp__prompt'

def setup_inputs():

    _w = lambda a: (lambda t: t.to(torch.bfloat16) if t.is_floating_point() else t)(torch.as_tensor(a))

    def _A_setup():
        Bsz, L, D, N = (1, 2048, 640, 128)
        return {'u': _w((lambda *s: torch.randn(*s, dtype=torch.bfloat16) * 0.05)(Bsz, L, D)), 'log_A_real': _w((lambda *s: torch.randn(*s, dtype=torch.bfloat16) * 3.2)(D, N) * 0.5), 'A_imag': _w((lambda *s: torch.randn(*s, dtype=torch.bfloat16) * 0.1)(D, N) * 3.14), 'C_real': _w((lambda *s: torch.randn(*s, dtype=torch.bfloat16) * 3.2)(D, N) / N ** 0.5), 'C_imag': _w((lambda *s: torch.randn(*s, dtype=torch.bfloat16) * 3.2)(D, N) / N ** 0.5), 'log_dt': _w((lambda *s: torch.randn(*s, dtype=torch.bfloat16) * 0.1)(D) * 0.5 - 4.0), 'D_skip': _w((lambda *s: torch.randn(*s, dtype=torch.bfloat16) * 0.4)(D))}
    _A_in = _A_setup()

    def _B_setup():
        B, S, D, F = (1, 2048, 640, 1728)
        Fh = F // 2
        return {'x': _w((lambda *s: torch.randn(*s, dtype=torch.bfloat16) * 0.05)(B, S, D)), 'w_in': _w((lambda *s: torch.randn(*s, dtype=torch.bfloat16) * 0.2)(D, 2 * Fh)), 'w_sp': _w(0.01 * (lambda *s: torch.randn(*s, dtype=torch.bfloat16) * 0.2)(S, S)), 'b_sp': _w(1.0 + 0.01 * (lambda *s: torch.randn(*s, dtype=torch.bfloat16) * 0.05)(S)), 'w_out': _w((lambda *s: torch.randn(*s, dtype=torch.bfloat16) * 0.05)(Fh, D))}
    _B_in = _B_setup()
    return {'A_u': _A_in['u'], 'A_log_A_real': _A_in['log_A_real'], 'A_A_imag': _A_in['A_imag'], 'A_C_real': _A_in['C_real'], 'A_C_imag': _A_in['C_imag'], 'A_log_dt': _A_in['log_dt'], 'A_D_skip': _A_in['D_skip'], 'B_x': _B_in['x'], 'B_w_in': _B_in['w_in'], 'B_w_sp': _B_in['w_sp'], 'B_b_sp': _B_in['b_sp'], 'B_w_out': _B_in['w_out']}

def reference(A_u, A_log_A_real, A_A_imag, A_C_real, A_C_imag, A_log_dt, A_D_skip, B_x, B_w_in, B_w_sp, B_b_sp, B_w_out):

    def _A_ref(u, log_A_real, A_imag, C_real, C_imag, log_dt, D_skip):
        L = u.shape[1]
        dt = torch.exp(log_dt)
        A = -torch.exp(log_A_real) + 1j * A_imag
        C = (C_real + 1j * C_imag) * dt[:, None]
        pos = (lambda x, dt: x.to(dt))(torch.arange(L), log_dt.dtype)
        P = torch.exp((A * dt[:, None])[:, :, None] * pos[None, None, :])
        K = 2.0 * torch.einsum('dn,dnl->dl', C, P).real
        L2 = 2 * L
        u_t = (lambda x, *d: x.permute(*d))(u, 0, 2, 1)
        Kf = (lambda x, *a, **k: torch.fft.rfft(x.float(), *a, **k))(K, L2)
        Uf = (lambda x, *a, **k: torch.fft.rfft(x.float(), *a, **k))(u_t, L2)
        y = (lambda x, *a, **k: torch.fft.irfft(x, *a, **k).to(torch.bfloat16))(Uf * Kf[None, :, :], L2)[:, :, :L]
        y = (lambda x, *d: x.permute(*d))(y, 0, 2, 1)
        return y + u * D_skip[None, None, :]

    def _B_ref(x, w_in, w_sp, b_sp, w_out):
        B, S, D = x.shape
        F = w_in.shape[-1]
        Fh = F // 2
        z = _gelu(torch.einsum('bsd,df->bsf', x, w_in))
        z1 = z[..., :Fh].clone()
        z2 = _layernorm(z[..., Fh:], axis=-1)
        g = torch.einsum('ts,bsf->btf', w_sp, z2) + b_sp[None, :, None]
        return torch.einsum('bsf,fd->bsd', z1 * g, w_out)
    x = A_u
    xn = _layernorm(x, axis=-1)
    return x + _A_ref(xn, A_log_A_real, A_A_imag, A_C_real, A_C_imag, A_log_dt, A_D_skip) + _B_ref(xn, B_w_in, B_w_sp, B_b_sp, B_w_out)
```

```asm
; @launch grid=(256,1,1) block=(512,1,1) lds=163840
.amdgcn_target "amdgcn-amd-amdhsa--gfx950"
.text
.globl parallel_sum__ssm_conv_s4d__mixer_gmlp__prompt_kernel
.p2align 8
.type parallel_sum__ssm_conv_s4d__mixer_gmlp__prompt_kernel,@function
parallel_sum__ssm_conv_s4d__mixer_gmlp__prompt_kernel:
    s_cmp_ge_u32 s2, 256
    s_cbranch_scc1 m_end
    s_load_dwordx2 s[4:5], s[0:1], 0
    s_load_dwordx4 s[8:11], s[0:1], 64
    s_load_dwordx4 s[12:15], s[0:1], 104
    s_load_dwordx4 s[96:99], s[0:1], 88
    v_and_b32 v1, 63, v0
    v_lshrrev_b32 v2, 6, v0
    s_and_b32 s41, s2, 7
    v_readfirstlane_b32 s32, v2
    s_lshr_b32 s42, s2, 3
    s_and_b32 s33, s32, 3
    s_cmp_ge_u32 s42, 28
    s_cbranch_scc1 m_helper
    s_mul_i32 s43, s42, 37
    s_lshr_b32 s43, s43, 8
    s_mul_i32 s44, s43, 7
    s_sub_u32 s44, s42, s44
    s_lshr_b32 s35, s41, 1
    s_lshl_b32 s35, s35, 2
    s_add_u32 s35, s35, s43
    s_and_b32 s36, s41, 1
    s_mul_i32 s36, s36, 7
    s_add_u32 s36, s36, s44
    s_cmp_ge_u32 s32, 4
    s_cbranch_scc1 m_gemm1
    s_load_dwordx8 s[64:71], s[0:1], 8
    s_load_dwordx4 s[72:75], s[0:1], 40
    v_and_b32 v3, 7, v1
    s_lshl_b32 s39, s32, 13
    s_cmp_ge_u32 s32, 2
    s_cbranch_scc1 m_ldB
    s_lshl_b32 s43, s35, 7
    s_lshl_b32 s44, s32, 6
    s_add_u32 s43, s43, s44
    v_lshrrev_b32 v2, 5, v1
    v_lshlrev_b32 v2, 3, v2
    v_bfe_u32 v4, v1, 3, 2
    v_add3_u32 v2, v2, v4, s43
    v_mul_u32_u24 v2, 1280, v2
    v_lshrrev_b32 v4, 4, v1
    v_xor_b32 v3, v3, v4
    v_lshl_add_u32 v4, v3, 4, v2
    v_xor_b32 v3, 4, v3
    v_lshl_add_u32 v5, v3, 4, v2
    v_add_u32 v16, 0, v4
    v_add_u32 v17, 19456, v5
    v_add_u32 v18, 3072, v4
    v_add_u32 v19, 22528, v5
    v_add_u32 v20, 40960, v4
    v_add_u32 v21, 60416, v5
    v_add_u32 v22, 44032, v4
    v_add_u32 v23, 63488, v5
    s_waitcnt lgkmcnt(0)
    s_mov_b32 s16, s4
    s_mov_b32 s17, s5
    s_mov_b32 s18, 2621440
    s_mov_b32 s19, 0x00020000
    s_mov_b32 s38, 128
    s_branch m_ld
m_ldB:
    v_lshrrev_b32 v2, 3, v1
    v_mul_u32_u24 v2, 3456, v2
    s_cmp_eq_u32 s32, 2
    s_cselect_b32 s44, 1664, 0
    s_lshl_b32 s43, s36, 7
    s_add_u32 s43, s43, s44
    v_add_u32 v2, s43, v2
    v_bfe_u32 v4, v1, 4, 1
    v_lshlrev_b32 v4, 1, v4
    v_xor_b32 v3, v3, v4
    v_lshl_add_u32 v4, v3, 4, v2
    v_xor_b32 v3, 4, v3
    v_lshl_add_u32 v5, v3, 4, v2
    v_add_u32 v16, 0, v4
    v_add_u32 v17, 26624, v5
    v_add_u32 v18, 53248, v4
    v_add_u32 v19, 79872, v5
    v_add_u32 v20, 110592, v4
    v_add_u32 v21, 137216, v5
    v_add_u32 v22, 163840, v4
    v_add_u32 v23, 190464, v5
    s_waitcnt lgkmcnt(0)
    s_mov_b32 s16, s8
    s_mov_b32 s17, s9
    s_mov_b32 s18, 2211840
    s_mov_b32 s19, 0x00020000
    s_mov_b32 s38, 221184
m_ld:
    s_lshr_b32 s45, s41, 1
    s_mul_i32 s45, s45, 5
    s_lshr_b32 s45, s45, 1
    s_and_b32 s46, s41, 1
    s_mul_i32 s46, s46, 5
    s_add_u32 s45, s45, s46
    s_and_b32 s46, s42, 1
    s_mul_i32 s46, s46, 5
    s_add_u32 s45, s45, s46
    s_cmp_ge_u32 s45, 10
    s_cselect_b32 s46, 10, 0
    s_sub_u32 s45, s45, s46
    s_mul_i32 s37, s45, s38
    s_mov_b32 s40, 0
    s_add_u32 m0, s39, 0
    s_nop 0
    buffer_load_dwordx4 v16, s[16:19], s37 offen offset:0 lds
    buffer_load_dwordx4 v17, s[16:19], s37 offen offset:1024 lds
    buffer_load_dwordx4 v18, s[16:19], s37 offen offset:2048 lds
    buffer_load_dwordx4 v19, s[16:19], s37 offen offset:3072 lds
    s_add_u32 m0, s39, 4096
    s_nop 0
    buffer_load_dwordx4 v20, s[16:19], s37 offen offset:0 lds
    buffer_load_dwordx4 v21, s[16:19], s37 offen offset:1024 lds
    buffer_load_dwordx4 v22, s[16:19], s37 offen offset:2048 lds
    buffer_load_dwordx4 v23, s[16:19], s37 offen offset:3072 lds
    s_add_u32 s39, s39, 32768
    s_add_u32 s45, s45, 1
    s_cmp_eq_u32 s45, 10
    s_cselect_b32 s45, 0, s45
    s_mul_i32 s37, s45, s38
    s_add_u32 m0, s39, 0
    s_nop 0
    buffer_load_dwordx4 v16, s[16:19], s37 offen offset:0 lds
    buffer_load_dwordx4 v17, s[16:19], s37 offen offset:1024 lds
    buffer_load_dwordx4 v18, s[16:19], s37 offen offset:2048 lds
    buffer_load_dwordx4 v19, s[16:19], s37 offen offset:3072 lds
    s_add_u32 m0, s39, 4096
    s_nop 0
    buffer_load_dwordx4 v20, s[16:19], s37 offen offset:0 lds
    buffer_load_dwordx4 v21, s[16:19], s37 offen offset:1024 lds
    buffer_load_dwordx4 v22, s[16:19], s37 offen offset:2048 lds
    buffer_load_dwordx4 v23, s[16:19], s37 offen offset:3072 lds
    s_add_u32 s39, s39, 32768
    s_add_u32 s45, s45, 1
    s_cmp_eq_u32 s45, 10
    s_cselect_b32 s45, 0, s45
    s_mul_i32 s37, s45, s38
    s_add_u32 m0, s39, 0
    s_nop 0
    buffer_load_dwordx4 v16, s[16:19], s37 offen offset:0 lds
    buffer_load_dwordx4 v17, s[16:19], s37 offen offset:1024 lds
    buffer_load_dwordx4 v18, s[16:19], s37 offen offset:2048 lds
    buffer_load_dwordx4 v19, s[16:19], s37 offen offset:3072 lds
    s_add_u32 m0, s39, 4096
    s_nop 0
    buffer_load_dwordx4 v20, s[16:19], s37 offen offset:0 lds
    buffer_load_dwordx4 v21, s[16:19], s37 offen offset:1024 lds
    buffer_load_dwordx4 v22, s[16:19], s37 offen offset:2048 lds
    buffer_load_dwordx4 v23, s[16:19], s37 offen offset:3072 lds
    s_add_u32 s39, s39, 32768
    s_add_u32 s45, s45, 1
    s_cmp_eq_u32 s45, 10
    s_cselect_b32 s45, 0, s45
    s_mul_i32 s37, s45, s38
    s_mov_b32 s40, 3
    s_add_u32 s24, s14, 28311552
    s_addc_u32 s25, s15, 0
    s_mov_b32 s26, 32768
    s_mov_b32 s27, 0x00020000
    s_mov_b32 s48, s12
    s_mov_b32 s49, s13
    s_mov_b32 s50, 256
    s_mov_b32 s51, 0x00020000
    s_mov_b32 s20, s10
    s_mov_b32 s21, s11
    s_mov_b32 s22, 8388608
    s_mov_b32 s23, 0x00020000
    v_bfe_u32 v4, v1, 2, 2
    v_lshlrev_b32 v4, 3, v4
    v_bfe_u32 v5, v1, 4, 1
    v_lshl_add_u32 v4, v5, 2, v4
    v_and_b32 v5, 0x23, v1
    v_add_u32 v4, v4, v5
    v_lshlrev_b32 v232, 4, v4
    v_mov_b32 v233, 0
    s_lshl_b32 s52, s35, 11
    s_and_b32 s43, s32, 1
    s_lshl_b32 s43, s43, 10
    s_add_u32 s52, s52, s43
    s_mul_i32 s34, s41, 28
    s_add_u32 s34, s34, s42
    s_lshl_b32 s34, s34, 1
    s_add_u32 s34, s34, s32
    s_mul_i32 s56, s41, 24
    s_add_u32 s56, s56, s42
    s_add_u32 s56, s56, 448
    s_cmp_lt_u32 s42, 24
    s_cselect_b32 s56, s56, 1000
    s_cmp_eq_u32 s32, 2
    s_cselect_b32 s34, s56, s34
    s_cmp_eq_u32 s32, 3
    s_cselect_b32 s34, 1000, s34
    s_min_u32 s57, s34, 639
    s_lshl_b32 s56, s57, 8
    s_lshl_b32 s57, s57, 1
    v_lshl_add_u32 v230, v1, 2, s56
    v_mov_b32 v231, s57
    s_getpc_b64 s[28:29]
m_pc:
    s_sub_u32 s28, s28, m_pc-parallel_sum__ssm_conv_s4d__mixer_gmlp__prompt_kernel
    s_subb_u32 s29, s29, 0
    s_mov_b32 s30, text_end-parallel_sum__ssm_conv_s4d__mixer_gmlp__prompt_kernel
    s_mov_b32 s31, 0x00020000
    s_and_b32 s54, s42, 15
    s_lshl_b32 s54, s54, 2
    s_add_u32 s54, s54, s33
    s_lshl_b32 s54, s54, 10
    s_lshl_b32 s53, s42, 2
    s_add_u32 s53, s53, s32
    s_mul_i32 s53, s53, 9600
    s_lshl_b32 s43, s41, 20
    s_add_u32 s53, s53, s43
    v_lshlrev_b32 v2, 4, v1
    s_lshl_b32 s43, s32, 8
    s_add_u32 s43, s43, 161152
    v_lshl_add_u32 v6, v1, 2, s43
    v_mov_b32 v7, 163712
m_ldloop:
    s_waitcnt vmcnt(16)
    s_barrier
    s_add_u32 m0, s39, 0
    s_nop 0
    buffer_load_dwordx4 v16, s[16:19], s37 offen offset:0 lds
    buffer_load_dwordx4 v17, s[16:19], s37 offen offset:1024 lds
    buffer_load_dwordx4 v18, s[16:19], s37 offen offset:2048 lds
    buffer_load_dwordx4 v19, s[16:19], s37 offen offset:3072 lds
    s_add_u32 m0, s39, 4096
    s_nop 0
    buffer_load_dwordx4 v20, s[16:19], s37 offen offset:0 lds
    buffer_load_dwordx4 v21, s[16:19], s37 offen offset:1024 lds
    buffer_load_dwordx4 v22, s[16:19], s37 offen offset:2048 lds
    buffer_load_dwordx4 v23, s[16:19], s37 offen offset:3072 lds
    s_add_u32 s39, s39, 32768
    s_and_b32 s39, s39, 0x1ffff
    s_add_u32 s45, s45, 1
    s_cmp_eq_u32 s45, 10
    s_cselect_b32 s45, 0, s45
    s_mul_i32 s37, s45, s38
    s_add_u32 s40, s40, 1
    s_cmp_lt_u32 s40, 10
    s_cbranch_scc1 m_ldloop
    buffer_load_dword v234, v233, s[48:51], 0 offen sc1
    buffer_load_dwordx4 v[236:239], v232, s[24:27], s52 offen sc1
    s_waitcnt vmcnt(18)
    s_barrier
    global_load_dword v164, v230, s[64:65]
    global_load_dword v165, v230, s[66:67]
    global_load_dword v166, v230, s[68:69]
    global_load_dword v167, v230, s[70:71]
    global_load_ushort v13, v231, s[72:73]
    global_load_ushort v14, v231, s[74:75]
    buffer_load_dwordx4 v[224:227], v2, s[28:31], s54 offen
    s_waitcnt vmcnt(17)
    s_barrier
    buffer_load_dwordx4 v[224:227], v2, s[20:23], s53 offen offset:0
    buffer_load_dwordx4 v[224:227], v2, s[20:23], s53 offen offset:1024
    buffer_load_dwordx4 v[224:227], v2, s[20:23], s53 offen offset:2048
    buffer_load_dwordx4 v[224:227], v2, s[20:23], s53 offen offset:3072
    s_add_u32 s53, s53, 4096
    buffer_load_dwordx4 v[224:227], v2, s[20:23], s53 offen offset:0
    s_add_u32 s53, s53, 1024
    s_waitcnt vmcnt(14)
    s_barrier
    s_cmp_ge_u32 s32, 2
    s_cbranch_scc1 m_st1ok
    s_waitcnt vmcnt(12)
    s_mov_b32 s40, 0
    s_branch m_st1chk
m_st1poll:
    buffer_load_dword v234, v233, s[48:51], 0 offen sc1
    buffer_load_dwordx4 v[236:239], v232, s[24:27], s52 offen sc1
    s_waitcnt vmcnt(0)
m_st1chk:
    v_xor_b32 v4, v237, v234
    v_xor_b32 v5, v239, v234
    v_or_b32 v4, v4, v5
    v_cmp_ne_u32 vcc, 0, v4
    v_cmp_eq_u32 s[44:45], 0, v234
    s_add_u32 s40, s40, 1
    s_or_b64 vcc, vcc, s[44:45]
    s_cmp_ge_u32 s40, 262144
    s_cbranch_scc1 m_st1w
    s_cbranch_vccnz m_st1poll
m_st1w:
    ds_write_b32 v6, v236
    ds_write_b32 v6, v238 offset:512
    ds_write_b32 v7, v234
m_st1ok:
    buffer_load_dwordx4 v[224:227], v2, s[20:23], s53 offen offset:0
    buffer_load_dwordx4 v[224:227], v2, s[20:23], s53 offen offset:1024
    buffer_load_dwordx4 v[224:227], v2, s[20:23], s53 offen offset:2048
    buffer_load_dwordx4 v[224:227], v2, s[20:23], s53 offen offset:3072
    s_add_u32 s53, s53, 4096
    buffer_load_dwordx4 v[224:227], v2, s[20:23], s53 offen offset:0
    s_add_u32 s53, s53, 1024
    s_waitcnt lgkmcnt(0)
    s_barrier
m_Lpost:
    v_mov_b32 v4, 163712
    ds_read_b32 v5, v4
    s_add_u32 s60, s14, 25165824
    s_addc_u32 s61, s15, 0
    s_mov_b32 s62, 262144
    s_mov_b32 s63, 0x00020000
    v_and_b32 v2, 15, v1
    v_lshrrev_b32 v3, 4, v1
    s_lshr_b32 s35, s41, 1
    s_lshl_b32 s35, s35, 3
    s_lshr_b32 s43, s42, 2
    s_add_u32 s35, s35, s43
    s_waitcnt lgkmcnt(0)
    v_readfirstlane_b32 s3, v5
    s_cmp_lg_u32 s32, 3
    s_cbranch_scc1 m_conv
    s_mov_b32 s16, s10
    s_mov_b32 s17, s11
    s_mov_b32 s18, 8388608
    s_mov_b32 s19, 0x00020000
    v_lshrrev_b32 v4, 5, v1
    v_lshlrev_b32 v4, 3, v4
    v_bfe_u32 v5, v1, 3, 2
    v_add_u32 v4, v4, v5
    v_lshlrev_b32 v4, 12, v4
    v_and_b32 v5, 7, v1
    v_xor_b32 v5, v5, v3
    v_lshl_add_u32 v6, v5, 4, v4
    v_xor_b32 v5, 4, v5
    v_lshl_add_u32 v7, v5, 4, v4
    v_add_u32 v16, 0, v6
    v_add_u32 v17, 64512, v7
    v_add_u32 v18, 14336, v6
    v_add_u32 v19, 78848, v7
    v_add_u32 v20, 131072, v6
    v_add_u32 v21, 195584, v7
    v_add_u32 v22, 145408, v6
    v_add_u32 v23, 209920, v7
    s_lshl_b32 s37, s35, 18
    s_and_b32 s43, s35, 0
    s_lshl_b32 s43, s43, 8
    s_add_u32 s37, s37, s43
    s_mov_b32 s40, 0
m_pfloop:
    s_and_b32 s43, s40, 3
    s_lshr_b32 s44, s40, 2
    s_mul_i32 s49, s43, 16384
    s_lshl_b32 s46, s44, 13
    s_add_u32 s49, s49, s46
    s_lshl_b32 s46, s43, 13
    s_add_u32 s46, s46, 111616
    s_cmp_eq_u32 s44, 2
    s_cselect_b32 s49, s46, s49
    s_lshl_b32 s43, s43, 10
    s_lshl_b32 s44, s44, 7
    s_add_u32 s43, s43, s44
    s_add_u32 s43, s43, s37
    s_add_u32 m0, s49, 0
    s_nop 0
    buffer_load_dwordx4 v16, s[16:19], s43 offen offset:0 lds
    buffer_load_dwordx4 v17, s[16:19], s43 offen offset:1024 lds
    buffer_load_dwordx4 v18, s[16:19], s43 offen offset:2048 lds
    buffer_load_dwordx4 v19, s[16:19], s43 offen offset:3072 lds
    s_add_u32 m0, s49, 4096
    s_nop 0
    buffer_load_dwordx4 v20, s[16:19], s43 offen offset:0 lds
    buffer_load_dwordx4 v21, s[16:19], s43 offen offset:1024 lds
    buffer_load_dwordx4 v22, s[16:19], s43 offen offset:2048 lds
    buffer_load_dwordx4 v23, s[16:19], s43 offen offset:3072 lds
    s_waitcnt vmcnt(40)
    s_add_u32 s40, s40, 1
    s_cmp_lt_u32 s40, 12
    s_cbranch_scc1 m_pfloop
    v_mov_b32 v4, 163788
    v_mov_b32 v5, 1
    s_waitcnt vmcnt(0)
    ds_write_b32 v4, v5
    s_and_b32 s36, s41, 1
    s_lshl_b32 s36, s36, 2
    s_and_b32 s43, s42, 3
    s_add_u32 s36, s36, s43
    s_cmp_eq_u32 s36, 7
    s_cselect_b32 s43, 31, 47
    v_min_u32 v7, s43, v1
    v_lshlrev_b32 v7, 2, v7
    s_lshl_b32 s45, s35, 3
    s_add_u32 s45, s45, s36
    s_lshl_b32 s45, s45, 8
    s_add_u32 s45, s45, 65536
    v_mov_b32 v4, 163724
    s_mov_b32 s75, 0
m_wown1:
    s_sleep 2
    ds_read_b32 v5, v4
    s_add_u32 s75, s75, 1
    s_waitcnt lgkmcnt(0)
    s_cmp_ge_u32 s75, 2097152
    s_cbranch_scc1 m_wown1_ok
m_wown1_chk:
    v_readfirstlane_b32 s43, v5
    s_cmp_lt_u32 s43, 4
    s_cbranch_scc1 m_wown1
m_wown1_ok:
    s_sleep 24
    s_mov_b32 s40, 0
    s_branch m_pollz_1st
m_pollz:
    s_sleep 2
m_pollz_1st:
    buffer_load_dword v5, v7, s[60:63], s45 offen offset:0 sc1
    s_add_u32 s40, s40, 1
    s_waitcnt vmcnt(0)
    v_xor_b32 v6, s3, v5
    v_cmp_ne_u32 vcc, 0, v6
    s_cmp_ge_u32 s40, 262144
    s_cbranch_scc1 m_pollz_ok
    s_cbranch_vccnz m_pollz
m_pollz_ok:
    v_mov_b32 v4, 163716
    v_mov_b32 v5, 1
    ds_write_b32 v4, v5
    s_add_u32 s24, s14, 23068672
    s_addc_u32 s25, s15, 0
    s_mov_b32 s26, 1105920
    s_mov_b32 s27, 0x00020000
    s_mov_b32 s20, s96
    s_mov_b32 s21, s97
    s_mov_b32 s22, 1105920
    s_mov_b32 s23, 0x00020000
    s_mov_b32 s38, s2
    v_lshrrev_b32 v4, 3, v1
    v_mul_u32_u24 v111, 1280, v4
    v_and_b32 v5, 7, v1
    v_lshl_add_u32 v111, v5, 4, v111
    s_mov_b32 s43, 144384
    v_mul_u32_u24 v4, 128, v4
    v_lshl_add_u32 v4, v5, 4, v4
    v_add_u32 v4, s43, v4
    v_bfe_u32 v5, v1, 2, 2
    v_lshl_add_u32 v5, v3, 2, v5
    v_mul_u32_u24 v5, 128, v5
    v_and_b32 v6, 3, v1
    v_lshl_add_u32 v5, v6, 3, v5
    v_add_u32 v5, s43, v5
    v_lshlrev_b32 v6, 4, v1
    s_add_u32 s43, s38, 0
    s_mul_i32 s44, s43, 205
    s_lshr_b32 s44, s44, 11
    s_mul_i32 s45, s44, 10
    s_sub_u32 s45, s43, s45
    s_mul_i32 s46, s44, 40960
    s_lshl_b32 s47, s45, 7
    s_add_u32 s46, s46, s47
    s_lshl_b32 s47, s45, 2
    s_add_u32 s47, s47, 0
    s_mul_i32 s39, s47, 52
    s_lshr_b32 s39, s39, 8
    s_mul_i32 s39, s39, 130
    s_add_u32 s47, s47, s39
    s_mul_i32 s39, s44, 5
    s_add_u32 s47, s47, s39
    s_lshl_b32 s47, s47, 10
    s_cmp_lt_u32 s43, 270
    s_cselect_b32 s48, s47, 1073741824
    s_lshl_b32 s47, s45, 2
    s_add_u32 s47, s47, 1
    s_mul_i32 s39, s47, 52
    s_lshr_b32 s39, s39, 8
    s_mul_i32 s39, s39, 130
    s_add_u32 s47, s47, s39
    s_mul_i32 s39, s44, 5
    s_add_u32 s47, s47, s39
    s_lshl_b32 s47, s47, 10
    s_cmp_lt_u32 s43, 270
    s_cselect_b32 s49, s47, 1073741824
    s_lshl_b32 s47, s45, 2
    s_add_u32 s47, s47, 2
    s_mul_i32 s39, s47, 52
    s_lshr_b32 s39, s39, 8
    s_mul_i32 s39, s39, 130
    s_add_u32 s47, s47, s39
    s_mul_i32 s39, s44, 5
    s_add_u32 s47, s47, s39
    s_lshl_b32 s47, s47, 10
    s_cmp_lt_u32 s43, 270
    s_cselect_b32 s50, s47, 1073741824
    s_lshl_b32 s47, s45, 2
    s_add_u32 s47, s47, 3
    s_mul_i32 s39, s47, 52
    s_lshr_b32 s39, s39, 8
    s_mul_i32 s39, s39, 130
    s_add_u32 s47, s47, s39
    s_mul_i32 s39, s44, 5
    s_add_u32 s47, s47, s39
    s_lshl_b32 s47, s47, 10
    s_cmp_lt_u32 s43, 270
    s_cselect_b32 s51, s47, 1073741824
    buffer_load_dwordx4 v[16:19], v111, s[20:23], s46 offen
    s_add_u32 s46, s46, 10240
    buffer_load_dwordx4 v[20:23], v111, s[20:23], s46 offen
    s_add_u32 s46, s46, 10240
    buffer_load_dwordx4 v[24:27], v111, s[20:23], s46 offen
    s_add_u32 s46, s46, 10240
    buffer_load_dwordx4 v[28:31], v111, s[20:23], s46 offen
    s_add_u32 s46, s46, 10240
    s_add_u32 s43, s38, 256
    s_mul_i32 s44, s43, 205
    s_lshr_b32 s44, s44, 11
    s_mul_i32 s45, s44, 10
    s_sub_u32 s45, s43, s45
    s_mul_i32 s46, s44, 40960
    s_lshl_b32 s47, s45, 7
    s_add_u32 s46, s46, s47
    s_lshl_b32 s47, s45, 2
    s_add_u32 s47, s47, 0
    s_mul_i32 s39, s47, 52
    s_lshr_b32 s39, s39, 8
    s_mul_i32 s39, s39, 130
    s_add_u32 s47, s47, s39
    s_mul_i32 s39, s44, 5
    s_add_u32 s47, s47, s39
    s_lshl_b32 s47, s47, 10
    s_cmp_lt_u32 s43, 270
    s_cselect_b32 s52, s47, 1073741824
    s_lshl_b32 s47, s45, 2
    s_add_u32 s47, s47, 1
    s_mul_i32 s39, s47, 52
    s_lshr_b32 s39, s39, 8
    s_mul_i32 s39, s39, 130
    s_add_u32 s47, s47, s39
    s_mul_i32 s39, s44, 5
    s_add_u32 s47, s47, s39
    s_lshl_b32 s47, s47, 10
    s_cmp_lt_u32 s43, 270
    s_cselect_b32 s53, s47, 1073741824
    s_lshl_b32 s47, s45, 2
    s_add_u32 s47, s47, 2
    s_mul_i32 s39, s47, 52
    s_lshr_b32 s39, s39, 8
    s_mul_i32 s39, s39, 130
    s_add_u32 s47, s47, s39
    s_mul_i32 s39, s44, 5
    s_add_u32 s47, s47, s39
    s_lshl_b32 s47, s47, 10
    s_cmp_lt_u32 s43, 270
    s_cselect_b32 s54, s47, 1073741824
    s_lshl_b32 s47, s45, 2
    s_add_u32 s47, s47, 3
    s_mul_i32 s39, s47, 52
    s_lshr_b32 s39, s39, 8
    s_mul_i32 s39, s39, 130
    s_add_u32 s47, s47, s39
    s_mul_i32 s39, s44, 5
    s_add_u32 s47, s47, s39
    s_lshl_b32 s47, s47, 10
    s_cmp_lt_u32 s43, 270
    s_cselect_b32 s55, s47, 1073741824
    buffer_load_dwordx4 v[32:35], v111, s[20:23], s46 offen
    s_add_u32 s46, s46, 10240
    buffer_load_dwordx4 v[36:39], v111, s[20:23], s46 offen
    s_add_u32 s46, s46, 10240
    buffer_load_dwordx4 v[40:43], v111, s[20:23], s46 offen
    s_add_u32 s46, s46, 10240
    buffer_load_dwordx4 v[44:47], v111, s[20:23], s46 offen
    s_add_u32 s46, s46, 10240
    s_waitcnt vmcnt(4)
    ds_write_b128 v4, v[16:19] offset:0
    ds_write_b128 v4, v[20:23] offset:1024
    ds_write_b128 v4, v[24:27] offset:2048
    ds_write_b128 v4, v[28:31] offset:3072
    ds_read_b64_tr_b16 v[64:65], v5 offset:0
    ds_read_b64_tr_b16 v[66:67], v5 offset:2048
    ds_read_b64_tr_b16 v[68:69], v5 offset:32
    ds_read_b64_tr_b16 v[70:71], v5 offset:2080
    ds_read_b64_tr_b16 v[72:73], v5 offset:64
    ds_read_b64_tr_b16 v[74:75], v5 offset:2112
    ds_read_b64_tr_b16 v[76:77], v5 offset:96
    ds_read_b64_tr_b16 v[78:79], v5 offset:2144
    s_waitcnt vmcnt(0)
    ds_write_b128 v4, v[32:35] offset:0
    ds_write_b128 v4, v[36:39] offset:1024
    ds_write_b128 v4, v[40:43] offset:2048
    ds_write_b128 v4, v[44:47] offset:3072
    ds_read_b64_tr_b16 v[80:81], v5 offset:0
    ds_read_b64_tr_b16 v[82:83], v5 offset:2048
    ds_read_b64_tr_b16 v[84:85], v5 offset:32
    ds_read_b64_tr_b16 v[86:87], v5 offset:2080
    ds_read_b64_tr_b16 v[88:89], v5 offset:64
    ds_read_b64_tr_b16 v[90:91], v5 offset:2112
    ds_read_b64_tr_b16 v[92:93], v5 offset:96
    ds_read_b64_tr_b16 v[94:95], v5 offset:2144
    s_waitcnt lgkmcnt(0)
    buffer_store_dwordx4 v[64:67], v6, s[24:27], s48 offen sc1
    buffer_store_dwordx4 v[68:71], v6, s[24:27], s49 offen sc1
    buffer_store_dwordx4 v[72:75], v6, s[24:27], s50 offen sc1
    buffer_store_dwordx4 v[76:79], v6, s[24:27], s51 offen sc1
    buffer_store_dwordx4 v[80:83], v6, s[24:27], s52 offen sc1
    buffer_store_dwordx4 v[84:87], v6, s[24:27], s53 offen sc1
    buffer_store_dwordx4 v[88:91], v6, s[24:27], s54 offen sc1
    buffer_store_dwordx4 v[92:95], v6, s[24:27], s55 offen sc1
    s_lshl_b32 s45, s2, 2
    s_add_u32 s45, s45, 5120
    v_mov_b32 v7, 0
    v_mov_b32 v8, s3
    s_waitcnt vmcnt(0)
    s_mov_b64 exec, 1
    buffer_store_dword v8, v7, s[60:63], s45 offen offset:0 sc1
    s_mov_b64 exec, -1
    v_mov_b32 v4, 163728
    s_mov_b32 s75, 0
m_wgl3:
    s_sleep 8
    ds_read_b128 v[8:11], v4
    s_add_u32 s75, s75, 1
    s_waitcnt lgkmcnt(0)
    s_cmp_ge_u32 s75, 2097152
    s_cbranch_scc1 m_wgl3_ok
m_wgl3_chk:
    v_min_u32 v8, v8, v10
    v_min_u32 v9, v9, v11
    v_min_u32 v8, v8, v9
    s_nop 0
    v_readfirstlane_b32 s43, v8
    s_cmp_lt_u32 s43, 1
    s_cbranch_scc1 m_wgl3
m_wgl3_ok:
    s_mov_b32 s44, 5120
    s_mov_b32 s40, 0
    s_branch m_pollx3_1st
m_pollx3:
    s_sleep 16
m_pollx3_1st:
    buffer_load_dwordx4 v[8:11], v6, s[60:63], s44 offen offset:0 sc1
    s_add_u32 s40, s40, 1
    s_waitcnt vmcnt(0)
    v_xor_b32 v5, s3, v8
    v_xor_b32 v9, s3, v9
    v_or_b32 v5, v5, v9
    v_xor_b32 v10, s3, v10
    v_or_b32 v5, v5, v10
    v_xor_b32 v11, s3, v11
    v_or_b32 v5, v5, v11
    v_cmp_ne_u32 vcc, 0, v5
    s_cmp_ge_u32 s40, 262144
    s_cbranch_scc1 m_pollx3_ok
    s_cbranch_vccnz m_pollx3
m_pollx3_ok:
    v_mov_b32 v4, 163776
    v_mov_b32 v5, 1
    ds_write_b32 v4, v5
    s_branch m_L3prep
m_conv:
    s_cmp_ge_u32 s34, 640
    s_cbranch_scc1 m_L3prep
    s_mul_i32 s39, s32, 15360
    s_add_u32 s39, s39, 65536
    s_waitcnt vmcnt(10)
    v_lshlrev_b32 v13, 16, v13
    v_mul_f32 v4, 0x3fb8aa3b, v13
    v_mov_b32 v5, 0x3fb8aa3b
    v_fma_f32 v5, v13, v5, -v4
    v_fmac_f32 v5, 0x32a57060, v13
    v_exp_f32 v4, v4
    v_mul_f32 v5, 0x3f317218, v5
    v_fma_f32 v13, v4, v5, v4
    v_cvt_pk_bf16_f32 v13, v13, v13
    v_and_b32 v13, 0xffff0000, v13
    v_lshl_add_u32 v8, v1, 2, s39
    v_mul_u32_u24 v9, 272, v2
    v_lshl_add_u32 v9, v3, 4, v9
    v_add_u32 v9, s39, v9
    v_mov_b32 v4, 0x00003f80
    ds_write_b32 v8, v4 offset:5712
    s_mov_b32 s40, 2
    s_mov_b32 s50, 4096
    v_and_b32 v220, 31, v1
    v_lshlrev_b32 v220, 2, v220
    v_lshlrev_b32 v15, 4, v1
    s_mov_b32 s51, 0
    s_mov_b32 s20, s14
    s_mov_b32 s21, s15
    s_mov_b32 s22, 2621440
    s_mov_b32 s23, 0x00020000
    s_add_u32 s24, s14, 16777216
    s_addc_u32 s25, s15, 0
    s_mov_b32 s26, 2621440
    s_mov_b32 s27, 0x00020000
    s_lshl_b32 s45, s34, 12
    v_mov_b32 v136, 0
    v_mov_b32 v137, 0
    v_mov_b32 v138, 0
    v_mov_b32 v139, 0
    v_mov_b32 v140, 0
    v_mov_b32 v141, 0
    v_mov_b32 v142, 0
    v_mov_b32 v143, 0
    v_mov_b32 v144, 0
    v_mov_b32 v145, 0
    v_mov_b32 v146, 0
    v_mov_b32 v147, 0
    v_mov_b32 v148, 0
    v_mov_b32 v149, 0
    v_mov_b32 v150, 0
    v_mov_b32 v151, 0
parallel_sum__ssm_conv_s4d__mixer_gmlp__prompt_kernel_kg1:
    s_cmp_lg_u32 s40, 1
    s_cbranch_scc1 m_noprobe
    buffer_load_dword v216, v220, s[60:63], s50 offen sc1
    m_noprobe:
    v_lshlrev_b32 v6, 16, v164
    v_mul_f32 v4, 0x3fb8aa3b, v6
    v_mov_b32 v5, 0x3fb8aa3b
    v_fma_f32 v5, v6, v5, -v4
    v_fmac_f32 v5, 0x32a57060, v6
    v_exp_f32 v4, v4
    v_mul_f32 v5, 0x3f317218, v5
    v_fma_f32 v6, v4, v5, v4
    v_cvt_pk_bf16_f32 v6, v6, v6
    v_and_b32 v6, 0xffff0000, v6
    v_mul_f32 v6, v6, v13
    v_mul_f32 v6, 0xbfb8aa3b, v6
    v_lshlrev_b32 v7, 16, v165
    v_mul_f32 v7, v7, v13
    v_mul_f32 v7, 0.15915494, v7
    v_lshlrev_b32 v24, 16, v166
    v_lshlrev_b32 v25, 16, v167
    v_mul_f32 v24, v24, v13
    v_mul_f32 v25, v25, v13
    v_add_f32 v24, v24, v24
    v_add_f32 v25, v25, v25
    v_mul_f32 v152, 0x3f800000, v6
    v_mul_f32 v154, 0x41000000, v6
    v_mul_f32 v156, 0x43800000, v6
    v_mul_f32 v153, 0x3f800000, v7
    v_mul_f32 v155, 0x41000000, v7
    v_mul_f32 v157, 0x43800000, v7
    v_exp_f32 v152, v152
    v_exp_f32 v154, v154
    v_exp_f32 v156, v156
    v_fract_f32 v153, v153
    v_fract_f32 v155, v155
    v_fract_f32 v157, v157
    v_cos_f32 v26, v153
    v_cos_f32 v28, v155
    v_cos_f32 v30, v157
    v_sin_f32 v27, v153
    v_sin_f32 v29, v155
    v_sin_f32 v31, v157
    v_mul_f32 v26, v26, v152
    v_mul_f32 v28, v28, v154
    v_mul_f32 v30, v30, v156
    v_mul_f32 v27, v27, v152
    v_mul_f32 v29, v29, v154
    v_mul_f32 v31, v31, v156
    v_cvt_pk_bf16_f32 v152, v24, -v25
    v_cvt_pk_bf16_f32 v153, v28, v29
    ds_write_b32 v8, v152 offset:0
    ds_write_b32 v8, v153 offset:5984
    v_pk_mul_f32 v[32:33], v[24:25], v[26:27] op_sel:[0,0] op_sel_hi:[1,0]
    v_pk_mul_f32 v[34:35], v[26:27], v[26:27] op_sel:[0,0] op_sel_hi:[1,0]
    v_pk_mul_f32 v[36:37], v[28:29], v[28:29] op_sel:[0,0] op_sel_hi:[1,0]
    v_pk_mul_f32 v[38:39], v[30:31], v[30:31] op_sel:[0,0] op_sel_hi:[1,0]
    v_pk_mul_f32 v[40:41], v[24:25], v[30:31] op_sel:[0,0] op_sel_hi:[1,0]
    v_pk_fma_f32 v[42:43], v[24:25], v[26:27], v[32:33] op_sel:[1,1,0] op_sel_hi:[0,1,1] neg_lo:[0,1,0]
    v_pk_fma_f32 v[44:45], v[26:27], v[26:27], v[34:35] op_sel:[1,1,0] op_sel_hi:[0,1,1] neg_lo:[0,1,0]
    v_pk_fma_f32 v[46:47], v[28:29], v[28:29], v[36:37] op_sel:[1,1,0] op_sel_hi:[0,1,1] neg_lo:[0,1,0]
    v_pk_fma_f32 v[48:49], v[30:31], v[30:31], v[38:39] op_sel:[1,1,0] op_sel_hi:[0,1,1] neg_lo:[0,1,0]
    v_pk_fma_f32 v[50:51], v[24:25], v[30:31], v[40:41] op_sel:[1,1,0] op_sel_hi:[0,1,1] neg_lo:[0,1,0]
    v_cvt_pk_bf16_f32 v154, v42, -v43
    v_cvt_pk_bf16_f32 v155, v46, v47
    v_cvt_pk_bf16_f32 v156, v50, -v51
    ds_write_b32 v8, v154 offset:272
    ds_write_b32 v8, v155 offset:6256
    ds_write_b32 v8, v156 offset:2176
    v_pk_mul_f32 v[32:33], v[24:25], v[44:45] op_sel:[0,0] op_sel_hi:[1,0]
    v_pk_mul_f32 v[34:35], v[42:43], v[44:45] op_sel:[0,0] op_sel_hi:[1,0]
    v_pk_mul_f32 v[36:37], v[44:45], v[44:45] op_sel:[0,0] op_sel_hi:[1,0]
    v_pk_mul_f32 v[38:39], v[46:47], v[28:29] op_sel:[0,0] op_sel_hi:[1,0]
    v_pk_mul_f32 v[40:41], v[46:47], v[46:47] op_sel:[0,0] op_sel_hi:[1,0]
    v_pk_mul_f32 v[52:53], v[24:25], v[48:49] op_sel:[0,0] op_sel_hi:[1,0]
    v_pk_fma_f32 v[54:55], v[24:25], v[44:45], v[32:33] op_sel:[1,1,0] op_sel_hi:[0,1,1] neg_lo:[0,1,0]
    v_pk_fma_f32 v[56:57], v[42:43], v[44:45], v[34:35] op_sel:[1,1,0] op_sel_hi:[0,1,1] neg_lo:[0,1,0]
    v_pk_fma_f32 v[58:59], v[44:45], v[44:45], v[36:37] op_sel:[1,1,0] op_sel_hi:[0,1,1] neg_lo:[0,1,0]
    v_pk_fma_f32 v[60:61], v[46:47], v[28:29], v[38:39] op_sel:[1,1,0] op_sel_hi:[0,1,1] neg_lo:[0,1,0]
    v_pk_fma_f32 v[62:63], v[46:47], v[46:47], v[40:41] op_sel:[1,1,0] op_sel_hi:[0,1,1] neg_lo:[0,1,0]
    v_pk_fma_f32 v[64:65], v[24:25], v[48:49], v[52:53] op_sel:[1,1,0] op_sel_hi:[0,1,1] neg_lo:[0,1,0]
    v_cvt_pk_bf16_f32 v157, v54, -v55
    v_cvt_pk_bf16_f32 v158, v56, -v57
    v_cvt_pk_bf16_f32 v159, v60, v61
    v_cvt_pk_bf16_f32 v160, v62, v63
    v_cvt_pk_bf16_f32 v161, v64, -v65
    ds_write_b32 v8, v157 offset:544
    ds_write_b32 v8, v158 offset:816
    ds_write_b32 v8, v159 offset:6528
    ds_write_b32 v8, v160 offset:6800
    ds_write_b32 v8, v161 offset:3264
    v_pk_mul_f32 v[32:33], v[24:25], v[58:59] op_sel:[0,0] op_sel_hi:[1,0]
    v_pk_mul_f32 v[34:35], v[42:43], v[58:59] op_sel:[0,0] op_sel_hi:[1,0]
    v_pk_mul_f32 v[36:37], v[54:55], v[58:59] op_sel:[0,0] op_sel_hi:[1,0]
    v_pk_mul_f32 v[38:39], v[56:57], v[58:59] op_sel:[0,0] op_sel_hi:[1,0]
    v_pk_mul_f32 v[40:41], v[54:55], v[30:31] op_sel:[0,0] op_sel_hi:[1,0]
    v_pk_mul_f32 v[52:53], v[64:65], v[30:31] op_sel:[0,0] op_sel_hi:[1,0]
    v_pk_mul_f32 v[66:67], v[64:65], v[48:49] op_sel:[0,0] op_sel_hi:[1,0]
    v_pk_mul_f32 v[68:69], v[28:29], v[62:63] op_sel:[0,0] op_sel_hi:[1,0]
    v_pk_mul_f32 v[70:71], v[46:47], v[62:63] op_sel:[0,0] op_sel_hi:[1,0]
    v_pk_mul_f32 v[72:73], v[60:61], v[62:63] op_sel:[0,0] op_sel_hi:[1,0]
    v_pk_mul_f32 v[74:75], v[62:63], v[62:63] op_sel:[0,0] op_sel_hi:[1,0]
    v_pk_fma_f32 v[76:77], v[24:25], v[58:59], v[32:33] op_sel:[1,1,0] op_sel_hi:[0,1,1] neg_lo:[0,1,0]
    v_pk_fma_f32 v[78:79], v[42:43], v[58:59], v[34:35] op_sel:[1,1,0] op_sel_hi:[0,1,1] neg_lo:[0,1,0]
    v_pk_fma_f32 v[80:81], v[54:55], v[58:59], v[36:37] op_sel:[1,1,0] op_sel_hi:[0,1,1] neg_lo:[0,1,0]
    v_pk_fma_f32 v[82:83], v[56:57], v[58:59], v[38:39] op_sel:[1,1,0] op_sel_hi:[0,1,1] neg_lo:[0,1,0]
    v_pk_fma_f32 v[84:85], v[54:55], v[30:31], v[40:41] op_sel:[1,1,0] op_sel_hi:[0,1,1] neg_lo:[0,1,0]
    v_pk_fma_f32 v[86:87], v[64:65], v[30:31], v[52:53] op_sel:[1,1,0] op_sel_hi:[0,1,1] neg_lo:[0,1,0]
    v_pk_fma_f32 v[88:89], v[64:65], v[48:49], v[66:67] op_sel:[1,1,0] op_sel_hi:[0,1,1] neg_lo:[0,1,0]
    v_pk_fma_f32 v[28:29], v[28:29], v[62:63], v[68:69] op_sel:[1,1,0] op_sel_hi:[0,1,1] neg_lo:[0,1,0]
    v_pk_fma_f32 v[46:47], v[46:47], v[62:63], v[70:71] op_sel:[1,1,0] op_sel_hi:[0,1,1] neg_lo:[0,1,0]
    v_pk_fma_f32 v[60:61], v[60:61], v[62:63], v[72:73] op_sel:[1,1,0] op_sel_hi:[0,1,1] neg_lo:[0,1,0]
    v_pk_fma_f32 v[90:91], v[62:63], v[62:63], v[74:75] op_sel:[1,1,0] op_sel_hi:[0,1,1] neg_lo:[0,1,0]
    v_cvt_pk_bf16_f32 v162, v76, -v77
    v_cvt_pk_bf16_f32 v163, v78, -v79
    v_cvt_pk_bf16_f32 v152, v80, -v81
    v_cvt_pk_bf16_f32 v153, v82, -v83
    v_cvt_pk_bf16_f32 v154, v84, -v85
    v_cvt_pk_bf16_f32 v155, v86, -v87
    v_cvt_pk_bf16_f32 v156, v88, -v89
    v_cvt_pk_bf16_f32 v157, v28, v29
    v_cvt_pk_bf16_f32 v158, v46, v47
    v_cvt_pk_bf16_f32 v159, v60, v61
    v_cvt_pk_bf16_f32 v160, v90, v91
    ds_write_b32 v8, v162 offset:1088
    ds_write_b32 v8, v163 offset:1360
    ds_write_b32 v8, v152 offset:1632
    ds_write_b32 v8, v153 offset:1904
    ds_write_b32 v8, v154 offset:2448
    ds_write_b32 v8, v155 offset:3808
    ds_write_b32 v8, v156 offset:4352
    ds_write_b32 v8, v157 offset:7072
    ds_write_b32 v8, v158 offset:7344
    ds_write_b32 v8, v159 offset:7616
    ds_write_b32 v8, v160 offset:7888
    v_pk_mul_f32 v[32:33], v[76:77], v[30:31] op_sel:[0,0] op_sel_hi:[1,0]
    v_pk_mul_f32 v[34:35], v[80:81], v[30:31] op_sel:[0,0] op_sel_hi:[1,0]
    v_pk_mul_f32 v[36:37], v[76:77], v[48:49] op_sel:[0,0] op_sel_hi:[1,0]
    v_pk_mul_f32 v[38:39], v[86:87], v[48:49] op_sel:[0,0] op_sel_hi:[1,0]
    v_pk_mul_f32 v[40:41], v[88:89], v[48:49] op_sel:[0,0] op_sel_hi:[1,0]
    v_pk_mul_f32 v[52:53], v[28:29], v[62:63] op_sel:[0,0] op_sel_hi:[1,0]
    v_pk_mul_f32 v[66:67], v[46:47], v[62:63] op_sel:[0,0] op_sel_hi:[1,0]
    v_pk_mul_f32 v[68:69], v[60:61], v[62:63] op_sel:[0,0] op_sel_hi:[1,0]
    v_pk_mul_f32 v[70:71], v[90:91], v[62:63] op_sel:[0,0] op_sel_hi:[1,0]
    v_pk_fma_f32 v[92:93], v[76:77], v[30:31], v[32:33] op_sel:[1,1,0] op_sel_hi:[0,1,1] neg_lo:[0,1,0]
    v_pk_fma_f32 v[94:95], v[80:81], v[30:31], v[34:35] op_sel:[1,1,0] op_sel_hi:[0,1,1] neg_lo:[0,1,0]
    v_pk_fma_f32 v[96:97], v[76:77], v[48:49], v[36:37] op_sel:[1,1,0] op_sel_hi:[0,1,1] neg_lo:[0,1,0]
    v_pk_fma_f32 v[98:99], v[86:87], v[48:49], v[38:39] op_sel:[1,1,0] op_sel_hi:[0,1,1] neg_lo:[0,1,0]
    v_pk_fma_f32 v[100:101], v[88:89], v[48:49], v[40:41] op_sel:[1,1,0] op_sel_hi:[0,1,1] neg_lo:[0,1,0]
    v_pk_fma_f32 v[28:29], v[28:29], v[62:63], v[52:53] op_sel:[1,1,0] op_sel_hi:[0,1,1] neg_lo:[0,1,0]
    v_pk_fma_f32 v[46:47], v[46:47], v[62:63], v[66:67] op_sel:[1,1,0] op_sel_hi:[0,1,1] neg_lo:[0,1,0]
    v_pk_fma_f32 v[60:61], v[60:61], v[62:63], v[68:69] op_sel:[1,1,0] op_sel_hi:[0,1,1] neg_lo:[0,1,0]
    v_pk_fma_f32 v[90:91], v[90:91], v[62:63], v[70:71] op_sel:[1,1,0] op_sel_hi:[0,1,1] neg_lo:[0,1,0]
    v_cvt_pk_bf16_f32 v161, v92, -v93
    v_cvt_pk_bf16_f32 v162, v94, -v95
    v_cvt_pk_bf16_f32 v163, v96, -v97
    v_cvt_pk_bf16_f32 v152, v98, -v99
    v_cvt_pk_bf16_f32 v153, v100, -v101
    v_cvt_pk_bf16_f32 v154, v28, v29
    v_cvt_pk_bf16_f32 v155, v46, v47
    v_cvt_pk_bf16_f32 v156, v60, v61
    v_cvt_pk_bf16_f32 v157, v90, v91
    ds_write_b32 v8, v161 offset:2720
    ds_write_b32 v8, v162 offset:2992
    ds_write_b32 v8, v163 offset:3536
    ds_write_b32 v8, v152 offset:4624
    ds_write_b32 v8, v153 offset:4896
    ds_write_b32 v8, v154 offset:8160
    ds_write_b32 v8, v155 offset:8432
    ds_write_b32 v8, v156 offset:8704
    ds_write_b32 v8, v157 offset:8976
    v_pk_mul_f32 v[32:33], v[96:97], v[30:31] op_sel:[0,0] op_sel_hi:[1,0]
    v_pk_mul_f32 v[34:35], v[98:99], v[48:49] op_sel:[0,0] op_sel_hi:[1,0]
    v_pk_mul_f32 v[36:37], v[100:101], v[48:49] op_sel:[0,0] op_sel_hi:[1,0]
    v_pk_mul_f32 v[38:39], v[28:29], v[62:63] op_sel:[0,0] op_sel_hi:[1,0]
    v_pk_mul_f32 v[40:41], v[46:47], v[62:63] op_sel:[0,0] op_sel_hi:[1,0]
    v_pk_mul_f32 v[52:53], v[60:61], v[62:63] op_sel:[0,0] op_sel_hi:[1,0]
    v_pk_mul_f32 v[66:67], v[90:91], v[62:63] op_sel:[0,0] op_sel_hi:[1,0]
    v_pk_fma_f32 v[102:103], v[96:97], v[30:31], v[32:33] op_sel:[1,1,0] op_sel_hi:[0,1,1] neg_lo:[0,1,0]
    v_pk_fma_f32 v[104:105], v[98:99], v[48:49], v[34:35] op_sel:[1,1,0] op_sel_hi:[0,1,1] neg_lo:[0,1,0]
    v_pk_fma_f32 v[106:107], v[100:101], v[48:49], v[36:37] op_sel:[1,1,0] op_sel_hi:[0,1,1] neg_lo:[0,1,0]
    v_pk_fma_f32 v[28:29], v[28:29], v[62:63], v[38:39] op_sel:[1,1,0] op_sel_hi:[0,1,1] neg_lo:[0,1,0]
    v_pk_fma_f32 v[46:47], v[46:47], v[62:63], v[40:41] op_sel:[1,1,0] op_sel_hi:[0,1,1] neg_lo:[0,1,0]
    v_pk_fma_f32 v[60:61], v[60:61], v[62:63], v[52:53] op_sel:[1,1,0] op_sel_hi:[0,1,1] neg_lo:[0,1,0]
    v_pk_fma_f32 v[90:91], v[90:91], v[62:63], v[66:67] op_sel:[1,1,0] op_sel_hi:[0,1,1] neg_lo:[0,1,0]
    v_cvt_pk_bf16_f32 v158, v102, -v103
    v_cvt_pk_bf16_f32 v159, v104, -v105
    v_cvt_pk_bf16_f32 v160, v106, -v107
    v_cvt_pk_bf16_f32 v161, v28, v29
    v_cvt_pk_bf16_f32 v162, v46, v47
    v_cvt_pk_bf16_f32 v163, v60, v61
    v_cvt_pk_bf16_f32 v152, v90, v91
    ds_write_b32 v8, v158 offset:4080
    ds_write_b32 v8, v159 offset:5168
    ds_write_b32 v8, v160 offset:5440
    ds_write_b32 v8, v161 offset:9248
    ds_write_b32 v8, v162 offset:9520
    ds_write_b32 v8, v163 offset:9792
    ds_write_b32 v8, v152 offset:10064
    v_pk_mul_f32 v[32:33], v[28:29], v[62:63] op_sel:[0,0] op_sel_hi:[1,0]
    v_pk_mul_f32 v[34:35], v[46:47], v[62:63] op_sel:[0,0] op_sel_hi:[1,0]
    v_pk_mul_f32 v[36:37], v[60:61], v[62:63] op_sel:[0,0] op_sel_hi:[1,0]
    v_pk_mul_f32 v[38:39], v[90:91], v[62:63] op_sel:[0,0] op_sel_hi:[1,0]
    v_pk_fma_f32 v[28:29], v[28:29], v[62:63], v[32:33] op_sel:[1,1,0] op_sel_hi:[0,1,1] neg_lo:[0,1,0]
    v_pk_fma_f32 v[46:47], v[46:47], v[62:63], v[34:35] op_sel:[1,1,0] op_sel_hi:[0,1,1] neg_lo:[0,1,0]
    v_pk_fma_f32 v[60:61], v[60:61], v[62:63], v[36:37] op_sel:[1,1,0] op_sel_hi:[0,1,1] neg_lo:[0,1,0]
    v_pk_fma_f32 v[90:91], v[90:91], v[62:63], v[38:39] op_sel:[1,1,0] op_sel_hi:[0,1,1] neg_lo:[0,1,0]
    v_cvt_pk_bf16_f32 v153, v28, v29
    v_cvt_pk_bf16_f32 v154, v46, v47
    v_cvt_pk_bf16_f32 v155, v60, v61
    v_cvt_pk_bf16_f32 v156, v90, v91
    ds_write_b32 v8, v153 offset:10336
    ds_write_b32 v8, v154 offset:10608
    ds_write_b32 v8, v155 offset:10880
    ds_write_b32 v8, v156 offset:11152
    v_pk_mul_f32 v[32:33], v[28:29], v[62:63] op_sel:[0,0] op_sel_hi:[1,0]
    v_pk_mul_f32 v[34:35], v[46:47], v[62:63] op_sel:[0,0] op_sel_hi:[1,0]
    v_pk_mul_f32 v[36:37], v[60:61], v[62:63] op_sel:[0,0] op_sel_hi:[1,0]
    v_pk_mul_f32 v[38:39], v[90:91], v[62:63] op_sel:[0,0] op_sel_hi:[1,0]
    v_pk_fma_f32 v[28:29], v[28:29], v[62:63], v[32:33] op_sel:[1,1,0] op_sel_hi:[0,1,1] neg_lo:[0,1,0]
    v_pk_fma_f32 v[46:47], v[46:47], v[62:63], v[34:35] op_sel:[1,1,0] op_sel_hi:[0,1,1] neg_lo:[0,1,0]
    v_pk_fma_f32 v[60:61], v[60:61], v[62:63], v[36:37] op_sel:[1,1,0] op_sel_hi:[0,1,1] neg_lo:[0,1,0]
    v_pk_fma_f32 v[90:91], v[90:91], v[62:63], v[38:39] op_sel:[1,1,0] op_sel_hi:[0,1,1] neg_lo:[0,1,0]
    v_cvt_pk_bf16_f32 v157, v28, v29
    v_cvt_pk_bf16_f32 v158, v46, v47
    v_cvt_pk_bf16_f32 v159, v60, v61
    v_cvt_pk_bf16_f32 v160, v90, v91
    ds_write_b32 v8, v157 offset:11424
    ds_write_b32 v8, v158 offset:11696
    ds_write_b32 v8, v159 offset:11968
    ds_write_b32 v8, v160 offset:12240
    v_pk_mul_f32 v[32:33], v[28:29], v[62:63] op_sel:[0,0] op_sel_hi:[1,0]
    v_pk_mul_f32 v[34:35], v[46:47], v[62:63] op_sel:[0,0] op_sel_hi:[1,0]
    v_pk_mul_f32 v[36:37], v[60:61], v[62:63] op_sel:[0,0] op_sel_hi:[1,0]
    v_pk_mul_f32 v[38:39], v[90:91], v[62:63] op_sel:[0,0] op_sel_hi:[1,0]
    v_pk_fma_f32 v[28:29], v[28:29], v[62:63], v[32:33] op_sel:[1,1,0] op_sel_hi:[0,1,1] neg_lo:[0,1,0]
    v_pk_fma_f32 v[46:47], v[46:47], v[62:63], v[34:35] op_sel:[1,1,0] op_sel_hi:[0,1,1] neg_lo:[0,1,0]
    v_pk_fma_f32 v[60:61], v[60:61], v[62:63], v[36:37] op_sel:[1,1,0] op_sel_hi:[0,1,1] neg_lo:[0,1,0]
    v_pk_fma_f32 v[90:91], v[90:91], v[62:63], v[38:39] op_sel:[1,1,0] op_sel_hi:[0,1,1] neg_lo:[0,1,0]
    v_cvt_pk_bf16_f32 v161, v28, v29
    v_cvt_pk_bf16_f32 v162, v46, v47
    v_cvt_pk_bf16_f32 v163, v60, v61
    v_cvt_pk_bf16_f32 v152, v90, v91
    ds_write_b32 v8, v161 offset:12512
    ds_write_b32 v8, v162 offset:12784
    ds_write_b32 v8, v163 offset:13056
    ds_write_b32 v8, v152 offset:13328
    v_pk_mul_f32 v[32:33], v[28:29], v[62:63] op_sel:[0,0] op_sel_hi:[1,0]
    v_pk_mul_f32 v[34:35], v[46:47], v[62:63] op_sel:[0,0] op_sel_hi:[1,0]
    v_pk_mul_f32 v[36:37], v[60:61], v[62:63] op_sel:[0,0] op_sel_hi:[1,0]
    v_pk_fma_f32 v[28:29], v[28:29], v[62:63], v[32:33] op_sel:[1,1,0] op_sel_hi:[0,1,1] neg_lo:[0,1,0]
    v_pk_fma_f32 v[46:47], v[46:47], v[62:63], v[34:35] op_sel:[1,1,0] op_sel_hi:[0,1,1] neg_lo:[0,1,0]
    v_pk_fma_f32 v[60:61], v[60:61], v[62:63], v[36:37] op_sel:[1,1,0] op_sel_hi:[0,1,1] neg_lo:[0,1,0]
    v_cvt_pk_bf16_f32 v153, v28, v29
    v_cvt_pk_bf16_f32 v154, v46, v47
    v_cvt_pk_bf16_f32 v155, v60, v61
    ds_write_b32 v8, v153 offset:13600
    ds_write_b32 v8, v154 offset:13872
    ds_write_b32 v8, v155 offset:14144
    v_lshrrev_b32 v164, 16, v164
    v_lshrrev_b32 v165, 16, v165
    v_lshrrev_b32 v166, 16, v166
    v_lshrrev_b32 v167, 16, v167
    s_cmp_lg_u32 s40, 1
    s_cbranch_scc1 m_nochk
    s_waitcnt vmcnt(0)
    v_cmp_ne_u32 vcc, s3, v216
    s_nop 1
    s_cbranch_vccnz m_nochk
    s_mov_b32 s51, 1
    buffer_load_dwordx4 v[200:203], v15, s[20:23], s45 offen offset:0 sc1
    buffer_load_dwordx4 v[204:207], v15, s[20:23], s45 offen offset:1024 sc1
    buffer_load_dwordx4 v[208:211], v15, s[20:23], s45 offen offset:2048 sc1
    buffer_load_dwordx4 v[212:215], v15, s[20:23], s45 offen offset:3072 sc1
    m_nochk:
    ds_read_b128 v[24:27], v9 offset:0
    ds_read_b128 v[28:31], v9 offset:4352
    ds_read_b128 v[32:35], v9 offset:5712
    ds_read_b128 v[36:39], v9 offset:10064
    ds_read_b128 v[40:43], v9 offset:64
    ds_read_b128 v[44:47], v9 offset:4416
    ds_read_b128 v[48:51], v9 offset:5776
    ds_read_b128 v[52:55], v9 offset:10128
    ds_read_b128 v[56:59], v9 offset:128
    ds_read_b128 v[60:63], v9 offset:4480
    ds_read_b128 v[64:67], v9 offset:5840
    ds_read_b128 v[68:71], v9 offset:10192
    ds_read_b128 v[72:75], v9 offset:192
    ds_read_b128 v[76:79], v9 offset:4544
    ds_read_b128 v[80:83], v9 offset:5904
    ds_read_b128 v[84:87], v9 offset:10256
    s_waitcnt lgkmcnt(12)
    v_mfma_f32_16x16x32_bf16 v[136:139], v[24:27], v[32:35], v[136:139]
    v_mfma_f32_16x16x32_bf16 v[144:147], v[32:35], v[28:31], v[144:147]
    v_mfma_f32_16x16x32_bf16 v[140:143], v[24:27], v[36:39], v[140:143]
    v_mfma_f32_16x16x32_bf16 v[148:151], v[36:39], v[28:31], v[148:151]
    s_waitcnt lgkmcnt(8)
    v_mfma_f32_16x16x32_bf16 v[136:139], v[40:43], v[48:51], v[136:139]
    v_mfma_f32_16x16x32_bf16 v[144:147], v[48:51], v[44:47], v[144:147]
    v_mfma_f32_16x16x32_bf16 v[140:143], v[40:43], v[52:55], v[140:143]
    v_mfma_f32_16x16x32_bf16 v[148:151], v[52:55], v[44:47], v[148:151]
    s_waitcnt lgkmcnt(4)
    v_mfma_f32_16x16x32_bf16 v[136:139], v[56:59], v[64:67], v[136:139]
    v_mfma_f32_16x16x32_bf16 v[144:147], v[64:67], v[60:63], v[144:147]
    v_mfma_f32_16x16x32_bf16 v[140:143], v[56:59], v[68:71], v[140:143]
    v_mfma_f32_16x16x32_bf16 v[148:151], v[68:71], v[60:63], v[148:151]
    s_waitcnt lgkmcnt(0)
    v_mfma_f32_16x16x32_bf16 v[136:139], v[72:75], v[80:83], v[136:139]
    v_mfma_f32_16x16x32_bf16 v[144:147], v[80:83], v[76:79], v[144:147]
    v_mfma_f32_16x16x32_bf16 v[140:143], v[72:75], v[84:87], v[140:143]
    v_mfma_f32_16x16x32_bf16 v[148:151], v[84:87], v[76:79], v[148:151]
    s_sub_u32 s40, s40, 1
    s_cmp_lg_u32 s40, 0
    s_cbranch_scc1 parallel_sum__ssm_conv_s4d__mixer_gmlp__prompt_kernel_kg1
    s_add_u32 s43, s39, 12928
    v_max_u32 v4, 1, v3
    v_sub_u32 v4, 5, v4
    v_lshlrev_b32 v5, v4, v2
    v_lshlrev_b32 v6, 3, v3
    v_mov_b32 v7, 512
    v_cmp_eq_u32 vcc, 2, v3
    s_nop 1
    v_cndmask_b32 v6, v6, v7, vcc
    v_mov_b32 v7, 768
    v_mov_b32 v8, 4
    v_mov_b32 v9, 128
    v_cmp_eq_u32 vcc, 3, v3
    s_nop 1
    v_cndmask_b32 v6, v6, v7, vcc
    v_cndmask_b32 v8, v8, v9, vcc
    v_add3_u32 v5, v5, v6, s43
    v_lshlrev_b32 v6, v4, 16
    v_add_u32 v6, v5, v6
    v_add_u32 v7, v5, v8
    v_add_u32 v8, v6, v8
    v_cvt_pk_bf16_f32 v24, v136, v137
    v_cvt_pk_bf16_f32 v25, v138, v139
    v_cvt_pk_bf16_f32 v26, v140, v141
    v_cvt_pk_bf16_f32 v27, v142, v143
    v_cvt_pk_bf16_f32 v28, v144, v145
    v_cvt_pk_bf16_f32 v29, v146, v147
    v_cvt_pk_bf16_f32 v30, v148, v149
    v_cvt_pk_bf16_f32 v31, v150, v151
    ds_write_b32 v5, v24
    ds_write_b32 v7, v25
    ds_write_b32 v6, v26
    ds_write_b32 v8, v27
    v_lshlrev_b32 v9, 6, v2
    v_lshl_add_u32 v9, v3, 3, v9
    v_add_u32 v9, s43, v9
    v_mov_b32 v20, 0
    v_mov_b32 v21, 0
    v_mov_b32 v22, 0
    v_mov_b32 v23, 0
    v_add_u32 v16, s39, v15
    v_lshl_add_u32 v17, v1, 3, s39
    ds_write_b64 v17, v[20:21] offset:8320
    v_cmp_gt_u32 vcc, 5, v2
    s_and_saveexec_b64 s[46:47], vcc
    ds_write_b64 v9, v[28:29] offset:1024
    ds_write_b64 v9, v[30:31] offset:1056
    s_mov_b64 exec, 3
    ds_write_b128 v16, v[20:23] offset:4096
    ds_write_b128 v16, v[20:23] offset:8256
    s_mov_b64 exec, -1
    v_lshlrev_b32 v18, 1, v1
    s_add_u32 s44, s43, 1150
    v_sub_u32 v96, s44, v18
    v_and_b32 v19, 1, v1
    v_xor_b32 v19, 1, v19
    v_lshl_add_u32 v97, v19, 1, v96
    v_lshlrev_b32 v18, 2, v1
    s_add_u32 s44, s43, 1020
    v_sub_u32 v98, s44, v18
    v_lshlrev_b32 v18, 3, v1
    s_add_u32 s44, s43, 758
    v_sub_u32 v99, s44, v18
    v_lshlrev_b32 v18, 4, v1
    s_add_u32 s44, s43, 1006
    v_sub_u32 v100, s44, v18
    ds_read_u16 v144, v96 offset:128
    ds_read_u16 v145, v96 offset:130
    ds_read_u16 v146, v97 offset:128
    ds_read_u16 v147, v96 offset:0
    ds_read_u16 v148, v96 offset:2
    ds_read_u16 v149, v97 offset:0
    ds_read_u16 v150, v98 offset:0
    ds_read_u16 v151, v98 offset:2
    ds_read_u16 v152, v98 offset:4
    s_mov_b32 exec_hi, 0
    ds_read_u16 v153, v99 offset:10
    ds_read_u16 v154, v99 offset:8
    ds_read_u16 v155, v99 offset:6
    ds_read_u16 v156, v99 offset:6
    ds_read_u16 v157, v99 offset:6
    ds_read_u16 v158, v99 offset:4
    ds_read_u16 v159, v99 offset:2
    ds_read_u16 v160, v99 offset:2
    ds_read_u16 v161, v99 offset:2
    s_mov_b32 exec_lo, 0x80000000
    ds_read_u16 v161, v99
    s_mov_b32 exec_lo, 0
    s_mov_b32 exec_hi, -1
    ds_read_u16 v153, v100 offset:16
    ds_read_u16 v154, v100 offset:14
    ds_read_u16 v155, v100 offset:12
    ds_read_u16 v156, v100 offset:10
    ds_read_u16 v157, v100 offset:8
    ds_read_u16 v158, v100 offset:6
    ds_read_u16 v159, v100 offset:4
    ds_read_u16 v160, v100 offset:2
    ds_read_u16 v161, v100 offset:0
    s_mov_b64 exec, -1
    v_cmp_eq_u32 vcc, 63, v1
    s_nop 0
    s_waitcnt lgkmcnt(0)
    v_cndmask_b32 v161, v161, v20, vcc
    v_lshl_or_b32 v32, v145, 16, v145
    v_lshl_or_b32 v40, v145, 16, v145
    v_lshl_or_b32 v33, v146, 16, v145
    v_lshl_or_b32 v41, v144, 16, v146
    v_lshl_or_b32 v34, v144, 16, v144
    v_lshl_or_b32 v42, v144, 16, v144
    v_lshl_or_b32 v35, v144, 16, v144
    v_lshl_or_b32 v43, v144, 16, v144
    ds_write_b128 v16, v[32:35] offset:0
    ds_write_b128 v16, v[40:43] offset:4160
    v_lshl_or_b32 v48, v148, 16, v148
    v_lshl_or_b32 v56, v148, 16, v148
    v_lshl_or_b32 v49, v149, 16, v148
    v_lshl_or_b32 v57, v147, 16, v149
    v_lshl_or_b32 v50, v147, 16, v147
    v_lshl_or_b32 v58, v147, 16, v147
    v_lshl_or_b32 v51, v147, 16, v147
    v_lshl_or_b32 v59, v147, 16, v147
    ds_write_b128 v16, v[48:51] offset:1024
    ds_write_b128 v16, v[56:59] offset:5184
    v_lshl_or_b32 v64, v152, 16, v152
    v_lshl_or_b32 v72, v151, 16, v152
    v_lshl_or_b32 v65, v151, 16, v151
    v_lshl_or_b32 v73, v151, 16, v151
    v_lshl_or_b32 v66, v150, 16, v151
    v_lshl_or_b32 v74, v150, 16, v150
    v_lshl_or_b32 v67, v150, 16, v150
    v_lshl_or_b32 v75, v150, 16, v150
    ds_write_b128 v16, v[64:67] offset:2048
    ds_write_b128 v16, v[72:75] offset:6208
    v_lshl_or_b32 v80, v154, 16, v153
    v_lshl_or_b32 v88, v155, 16, v154
    v_lshl_or_b32 v81, v156, 16, v155
    v_lshl_or_b32 v89, v157, 16, v156
    v_lshl_or_b32 v82, v158, 16, v157
    v_lshl_or_b32 v90, v159, 16, v158
    v_lshl_or_b32 v83, v160, 16, v159
    v_lshl_or_b32 v91, v161, 16, v160
    ds_write_b128 v16, v[80:83] offset:3072
    ds_write_b128 v16, v[88:91] offset:7232
    s_cmp_eq_u32 s51, 1
    s_cbranch_scc1 m_uok
    s_mov_b32 s40, 0
    s_branch m_pollx_1st
m_pollx:
    s_sleep 32
m_pollx_1st:
    buffer_load_dword v216, v220, s[60:63], s50 offen offset:0 sc1
    s_add_u32 s40, s40, 1
    s_waitcnt vmcnt(0)
    v_xor_b32 v4, s3, v216
    v_cmp_ne_u32 vcc, 0, v4
    s_cmp_ge_u32 s40, 262144
    s_cbranch_scc1 m_pollx_ok
    s_cbranch_vccnz m_pollx
m_pollx_ok:
    buffer_load_dwordx4 v[200:203], v15, s[20:23], s45 offen offset:0 sc1
    buffer_load_dwordx4 v[204:207], v15, s[20:23], s45 offen offset:1024 sc1
    buffer_load_dwordx4 v[208:211], v15, s[20:23], s45 offen offset:2048 sc1
    buffer_load_dwordx4 v[212:215], v15, s[20:23], s45 offen offset:3072 sc1
m_uok:
    s_waitcnt vmcnt(0)
    ds_write_b128 v16, v[200:203] offset:8832
    ds_write_b128 v16, v[204:207] offset:9856
    ds_write_b128 v16, v[208:211] offset:10880
    ds_write_b128 v16, v[212:215] offset:11904
    v_and_b32 v4, 1, v2
    v_xor_b32 v4, 1, v4
    v_mul_u32_u24 v4, 4160, v4
    v_lshrrev_b32 v5, 1, v2
    v_lshlrev_b32 v6, 2, v3
    v_sub_u32 v5, v6, v5
    v_lshl_add_u32 v4, v5, 2, v4
    v_add_u32 v4, s39, v4
    v_add_u32 v24, 3548, v4
    v_add_u32 v25, 2524, v4
    v_add_u32 v26, 1500, v4
    v_add_u32 v27, 476, v4
    v_lshlrev_b32 v5, 5, v2
    v_lshl_add_u32 v5, v3, 4, v5
    s_add_u32 s43, s39, 8800
    v_add_u32 v28, s43, v5
    v_mov_b32 v96, 0
    v_mov_b32 v97, 0
    v_mov_b32 v98, 0
    v_mov_b32 v99, 0
    v_mov_b32 v100, 0
    v_mov_b32 v101, 0
    v_mov_b32 v102, 0
    v_mov_b32 v103, 0
    v_mov_b32 v104, 0
    v_mov_b32 v105, 0
    v_mov_b32 v106, 0
    v_mov_b32 v107, 0
    v_mov_b32 v108, 0
    v_mov_b32 v109, 0
    v_mov_b32 v110, 0
    v_mov_b32 v111, 0
    v_mov_b32 v112, 0
    v_mov_b32 v113, 0
    v_mov_b32 v114, 0
    v_mov_b32 v115, 0
    v_mov_b32 v116, 0
    v_mov_b32 v117, 0
    v_mov_b32 v118, 0
    v_mov_b32 v119, 0
    v_mov_b32 v120, 0
    v_mov_b32 v121, 0
    v_mov_b32 v122, 0
    v_mov_b32 v123, 0
    v_mov_b32 v124, 0
    v_mov_b32 v125, 0
    v_mov_b32 v126, 0
    v_mov_b32 v127, 0
    v_lshlrev_b32 v14, 16, v14
    s_waitcnt lgkmcnt(0)
    ds_read2_b32 v[32:33], v24 offset0:128 offset1:129
    ds_read2_b32 v[34:35], v24 offset0:130 offset1:131
    ds_read_b128 v[92:95], v28 offset:3584
    ds_read2_b32 v[36:37], v24 offset0:0 offset1:1
    ds_read2_b32 v[38:39], v24 offset0:2 offset1:3
    ds_read_b128 v[88:91], v28 offset:3072
    ds_read2_b32 v[40:41], v25 offset0:128 offset1:129
    ds_read2_b32 v[42:43], v25 offset0:130 offset1:131
    ds_read_b128 v[84:87], v28 offset:2560
    ds_read2_b32 v[44:45], v25 offset0:0 offset1:1
    ds_read2_b32 v[46:47], v25 offset0:2 offset1:3
    ds_read_b128 v[80:83], v28 offset:2048
    ds_read2_b32 v[48:49], v26 offset0:128 offset1:129
    ds_read2_b32 v[50:51], v26 offset0:130 offset1:131
    ds_read_b128 v[76:79], v28 offset:1536
    ds_read2_b32 v[52:53], v26 offset0:0 offset1:1
    ds_read2_b32 v[54:55], v26 offset0:2 offset1:3
    ds_read_b128 v[72:75], v28 offset:1024
    ds_read2_b32 v[56:57], v27 offset0:128 offset1:129
    ds_read2_b32 v[58:59], v27 offset0:130 offset1:131
    ds_read_b128 v[68:71], v28 offset:512
    ds_read2_b32 v[60:61], v27 offset0:0 offset1:1
    ds_read2_b32 v[62:63], v27 offset0:2 offset1:3
    ds_read_b128 v[64:67], v28 offset:0
    s_mov_b32 s40, 8
m_cloop:
    v_subrev_u32 v24, 64, v24
    v_subrev_u32 v25, 64, v25
    v_subrev_u32 v26, 64, v26
    v_subrev_u32 v27, 64, v27
    v_subrev_u32 v28, 64, v28
    s_waitcnt lgkmcnt(15)
    v_mfma_f32_16x16x32_bf16 v[124:127], v[32:35], v[92:95], v[124:127]
    s_waitcnt lgkmcnt(15)
    v_mfma_f32_16x16x32_bf16 v[120:123], v[32:35], v[88:91], v[120:123]
    s_waitcnt lgkmcnt(15)
    v_mfma_f32_16x16x32_bf16 v[116:119], v[32:35], v[84:87], v[116:119]
    s_waitcnt lgkmcnt(12)
    v_mfma_f32_16x16x32_bf16 v[112:115], v[32:35], v[80:83], v[112:115]
    s_waitcnt lgkmcnt(9)
    v_mfma_f32_16x16x32_bf16 v[108:111], v[32:35], v[76:79], v[108:111]
    s_waitcnt lgkmcnt(6)
    v_mfma_f32_16x16x32_bf16 v[104:107], v[32:35], v[72:75], v[104:107]
    s_waitcnt lgkmcnt(3)
    v_mfma_f32_16x16x32_bf16 v[100:103], v[32:35], v[68:71], v[100:103]
    s_waitcnt lgkmcnt(0)
    v_mfma_f32_16x16x32_bf16 v[96:99], v[32:35], v[64:67], v[96:99]
    ds_read2_b32 v[32:33], v24 offset0:128 offset1:129
    ds_read2_b32 v[34:35], v24 offset0:130 offset1:131
    ds_read_b128 v[92:95], v28 offset:3584
    v_mfma_f32_16x16x32_bf16 v[100:103], v[36:39], v[64:67], v[100:103]
    v_mfma_f32_16x16x32_bf16 v[104:107], v[36:39], v[68:71], v[104:107]
    v_mfma_f32_16x16x32_bf16 v[108:111], v[36:39], v[72:75], v[108:111]
    v_mfma_f32_16x16x32_bf16 v[112:115], v[36:39], v[76:79], v[112:115]
    v_mfma_f32_16x16x32_bf16 v[116:119], v[36:39], v[80:83], v[116:119]
    v_mfma_f32_16x16x32_bf16 v[120:123], v[36:39], v[84:87], v[120:123]
    v_mfma_f32_16x16x32_bf16 v[124:127], v[36:39], v[88:91], v[124:127]
    ds_read2_b32 v[36:37], v24 offset0:0 offset1:1
    ds_read2_b32 v[38:39], v24 offset0:2 offset1:3
    ds_read_b128 v[88:91], v28 offset:3072
    v_mfma_f32_16x16x32_bf16 v[104:107], v[40:43], v[64:67], v[104:107]
    v_mfma_f32_16x16x32_bf16 v[108:111], v[40:43], v[68:71], v[108:111]
    v_mfma_f32_16x16x32_bf16 v[112:115], v[40:43], v[72:75], v[112:115]
    v_mfma_f32_16x16x32_bf16 v[116:119], v[40:43], v[76:79], v[116:119]
    v_mfma_f32_16x16x32_bf16 v[120:123], v[40:43], v[80:83], v[120:123]
    v_mfma_f32_16x16x32_bf16 v[124:127], v[40:43], v[84:87], v[124:127]
    ds_read2_b32 v[40:41], v25 offset0:128 offset1:129
    ds_read2_b32 v[42:43], v25 offset0:130 offset1:131
    ds_read_b128 v[84:87], v28 offset:2560
    v_mfma_f32_16x16x32_bf16 v[108:111], v[44:47], v[64:67], v[108:111]
    v_mfma_f32_16x16x32_bf16 v[112:115], v[44:47], v[68:71], v[112:115]
    v_mfma_f32_16x16x32_bf16 v[116:119], v[44:47], v[72:75], v[116:119]
    v_mfma_f32_16x16x32_bf16 v[120:123], v[44:47], v[76:79], v[120:123]
    v_mfma_f32_16x16x32_bf16 v[124:127], v[44:47], v[80:83], v[124:127]
    ds_read2_b32 v[44:45], v25 offset0:0 offset1:1
    ds_read2_b32 v[46:47], v25 offset0:2 offset1:3
    ds_read_b128 v[80:83], v28 offset:2048
    v_mfma_f32_16x16x32_bf16 v[112:115], v[48:51], v[64:67], v[112:115]
    v_mfma_f32_16x16x32_bf16 v[116:119], v[48:51], v[68:71], v[116:119]
    v_mfma_f32_16x16x32_bf16 v[120:123], v[48:51], v[72:75], v[120:123]
    v_mfma_f32_16x16x32_bf16 v[124:127], v[48:51], v[76:79], v[124:127]
    ds_read2_b32 v[48:49], v26 offset0:128 offset1:129
    ds_read2_b32 v[50:51], v26 offset0:130 offset1:131
    ds_read_b128 v[76:79], v28 offset:1536
    v_mfma_f32_16x16x32_bf16 v[116:119], v[52:55], v[64:67], v[116:119]
    v_mfma_f32_16x16x32_bf16 v[120:123], v[52:55], v[68:71], v[120:123]
    v_mfma_f32_16x16x32_bf16 v[124:127], v[52:55], v[72:75], v[124:127]
    ds_read2_b32 v[52:53], v26 offset0:0 offset1:1
    ds_read2_b32 v[54:55], v26 offset0:2 offset1:3
    ds_read_b128 v[72:75], v28 offset:1024
    v_mfma_f32_16x16x32_bf16 v[120:123], v[56:59], v[64:67], v[120:123]
    v_mfma_f32_16x16x32_bf16 v[124:127], v[56:59], v[68:71], v[124:127]
    ds_read2_b32 v[56:57], v27 offset0:128 offset1:129
    ds_read2_b32 v[58:59], v27 offset0:130 offset1:131
    ds_read_b128 v[68:71], v28 offset:512
    v_mfma_f32_16x16x32_bf16 v[124:127], v[60:63], v[64:67], v[124:127]
    ds_read2_b32 v[60:61], v27 offset0:0 offset1:1
    ds_read2_b32 v[62:63], v27 offset0:2 offset1:3
    ds_read_b128 v[64:67], v28 offset:0
    s_sub_u32 s40, s40, 1
    s_cmp_lg_u32 s40, 0
    s_cbranch_scc1 m_cloop
    s_waitcnt lgkmcnt(0)
    v_lshlrev_b32 v20, 5, v2
    v_lshl_add_u32 v20, v3, 3, v20
    s_add_u32 s43, s39, 8832
    v_add_u32 v21, s43, v20
    ds_read_b64 v[32:33], v21 offset:0
    ds_read_b64 v[34:35], v21 offset:512
    ds_read_b64 v[36:37], v21 offset:1024
    ds_read_b64 v[38:39], v21 offset:1536
    ds_read_b64 v[40:41], v21 offset:2048
    ds_read_b64 v[42:43], v21 offset:2560
    ds_read_b64 v[44:45], v21 offset:3072
    ds_read_b64 v[46:47], v21 offset:3584
    s_waitcnt lgkmcnt(0)
    v_lshlrev_b32 v72, 16, v32
    v_and_b32 v73, 0xffff0000, v32
    v_lshlrev_b32 v74, 16, v33
    v_and_b32 v75, 0xffff0000, v33
    v_lshlrev_b32 v76, 16, v34
    v_and_b32 v77, 0xffff0000, v34
    v_lshlrev_b32 v78, 16, v35
    v_and_b32 v79, 0xffff0000, v35
    v_lshlrev_b32 v80, 16, v36
    v_and_b32 v81, 0xffff0000, v36
    v_lshlrev_b32 v82, 16, v37
    v_and_b32 v83, 0xffff0000, v37
    v_lshlrev_b32 v84, 16, v38
    v_and_b32 v85, 0xffff0000, v38
    v_lshlrev_b32 v86, 16, v39
    v_and_b32 v87, 0xffff0000, v39
    v_pk_fma_f32 v[96:97], v[72:73], v[14:15], v[96:97] op_sel_hi:[1,0,1]
    v_pk_fma_f32 v[98:99], v[74:75], v[14:15], v[98:99] op_sel_hi:[1,0,1]
    v_pk_fma_f32 v[100:101], v[76:77], v[14:15], v[100:101] op_sel_hi:[1,0,1]
    v_pk_fma_f32 v[102:103], v[78:79], v[14:15], v[102:103] op_sel_hi:[1,0,1]
    v_pk_fma_f32 v[104:105], v[80:81], v[14:15], v[104:105] op_sel_hi:[1,0,1]
    v_pk_fma_f32 v[106:107], v[82:83], v[14:15], v[106:107] op_sel_hi:[1,0,1]
    v_pk_fma_f32 v[108:109], v[84:85], v[14:15], v[108:109] op_sel_hi:[1,0,1]
    v_pk_fma_f32 v[110:111], v[86:87], v[14:15], v[110:111] op_sel_hi:[1,0,1]
    v_cvt_pk_bf16_f32 v32, v96, v97
    v_cvt_pk_bf16_f32 v33, v98, v99
    v_cvt_pk_bf16_f32 v34, v100, v101
    v_cvt_pk_bf16_f32 v35, v102, v103
    v_cvt_pk_bf16_f32 v36, v104, v105
    v_cvt_pk_bf16_f32 v37, v106, v107
    v_cvt_pk_bf16_f32 v38, v108, v109
    v_cvt_pk_bf16_f32 v39, v110, v111
    ds_write_b64 v21, v[32:33] offset:0
    ds_write_b64 v21, v[34:35] offset:512
    ds_write_b64 v21, v[36:37] offset:1024
    ds_write_b64 v21, v[38:39] offset:1536
    v_lshlrev_b32 v72, 16, v40
    v_and_b32 v73, 0xffff0000, v40
    v_lshlrev_b32 v74, 16, v41
    v_and_b32 v75, 0xffff0000, v41
    v_lshlrev_b32 v76, 16, v42
    v_and_b32 v77, 0xffff0000, v42
    v_lshlrev_b32 v78, 16, v43
    v_and_b32 v79, 0xffff0000, v43
    v_lshlrev_b32 v80, 16, v44
    v_and_b32 v81, 0xffff0000, v44
    v_lshlrev_b32 v82, 16, v45
    v_and_b32 v83, 0xffff0000, v45
    v_lshlrev_b32 v84, 16, v46
    v_and_b32 v85, 0xffff0000, v46
    v_lshlrev_b32 v86, 16, v47
    v_and_b32 v87, 0xffff0000, v47
    v_pk_fma_f32 v[112:113], v[72:73], v[14:15], v[112:113] op_sel_hi:[1,0,1]
    v_pk_fma_f32 v[114:115], v[74:75], v[14:15], v[114:115] op_sel_hi:[1,0,1]
    v_pk_fma_f32 v[116:117], v[76:77], v[14:15], v[116:117] op_sel_hi:[1,0,1]
    v_pk_fma_f32 v[118:119], v[78:79], v[14:15], v[118:119] op_sel_hi:[1,0,1]
    v_pk_fma_f32 v[120:121], v[80:81], v[14:15], v[120:121] op_sel_hi:[1,0,1]
    v_pk_fma_f32 v[122:123], v[82:83], v[14:15], v[122:123] op_sel_hi:[1,0,1]
    v_pk_fma_f32 v[124:125], v[84:85], v[14:15], v[124:125] op_sel_hi:[1,0,1]
    v_pk_fma_f32 v[126:127], v[86:87], v[14:15], v[126:127] op_sel_hi:[1,0,1]
    v_cvt_pk_bf16_f32 v40, v112, v113
    v_cvt_pk_bf16_f32 v41, v114, v115
    v_cvt_pk_bf16_f32 v42, v116, v117
    v_cvt_pk_bf16_f32 v43, v118, v119
    v_cvt_pk_bf16_f32 v44, v120, v121
    v_cvt_pk_bf16_f32 v45, v122, v123
    v_cvt_pk_bf16_f32 v46, v124, v125
    v_cvt_pk_bf16_f32 v47, v126, v127
    ds_write_b64 v21, v[40:41] offset:2048
    ds_write_b64 v21, v[42:43] offset:2560
    ds_write_b64 v21, v[44:45] offset:3072
    ds_write_b64 v21, v[46:47] offset:3584
    ds_read_b128 v[64:67], v16 offset:8832
    ds_read_b128 v[68:71], v16 offset:9856
    ds_read_b128 v[72:75], v16 offset:10880
    ds_read_b128 v[76:79], v16 offset:11904
    s_waitcnt lgkmcnt(3)
    buffer_store_dwordx4 v[64:67], v15, s[24:27], s45 offen offset:0 sc1
    s_waitcnt lgkmcnt(2)
    buffer_store_dwordx4 v[68:71], v15, s[24:27], s45 offen offset:1024 sc1
    s_waitcnt lgkmcnt(1)
    buffer_store_dwordx4 v[72:75], v15, s[24:27], s45 offen offset:2048 sc1
    s_waitcnt lgkmcnt(0)
    buffer_store_dwordx4 v[76:79], v15, s[24:27], s45 offen offset:3072 sc1
    s_lshl_b32 s43, s34, 2
    s_add_u32 s43, s43, 6144
    v_mov_b32 v4, 0
    v_mov_b32 v5, s3
    s_waitcnt vmcnt(0)
    s_mov_b64 exec, 1
    buffer_store_dword v5, v4, s[60:63], s43 offen offset:0 sc1
    s_mov_b64 exec, -1
m_L3prep:
    s_and_b32 s36, s41, 1
    s_lshl_b32 s36, s36, 2
    s_and_b32 s43, s42, 3
    s_add_u32 s36, s36, s43
    v_mov_b32 v4, 163728
    s_mov_b32 s75, 0
m_wgl:
    s_sleep 8
    ds_read_b128 v[8:11], v4
    s_add_u32 s75, s75, 1
    s_waitcnt lgkmcnt(0)
    s_cmp_ge_u32 s75, 2097152
    s_cbranch_scc1 m_wgl_ok
m_wgl_chk:
    v_min_u32 v8, v8, v10
    v_min_u32 v9, v9, v11
    v_min_u32 v8, v8, v9
    s_nop 0
    v_readfirstlane_b32 s43, v8
    s_cmp_lt_u32 s43, 2
    s_cbranch_scc1 m_wgl
m_wgl_ok:
    v_mov_b32 v4, 163776
    s_mov_b32 s40, 0
m_wfw:
    s_sleep 2
    ds_read_b32 v5, v4
    s_add_u32 s40, s40, 1
    s_waitcnt lgkmcnt(0)
    v_readfirstlane_b32 s43, v5
    s_cmp_ge_u32 s40, 2097152
    s_cbranch_scc1 m_wfw_ok
    s_cmp_eq_u32 s43, 0
    s_cbranch_scc1 m_wfw
m_wfw_ok:
    s_add_u32 s16, s14, 23068672
    s_addc_u32 s17, s15, 0
    s_mov_b32 s18, 1105920
    s_mov_b32 s19, 0x00020000
    v_lshlrev_b32 v15, 4, v1
    s_mul_i32 s46, s33, 15
    s_add_u32 s46, s46, 42
    s_mov_b32 s47, 15
    s_cmp_eq_u32 s33, 3
    s_cselect_b32 s46, 119, s46
    s_cselect_b32 s47, 16, s47
    s_lshl_b32 s46, s46, 10
    s_mul_i32 s48, s36, 138240
    s_add_u32 s48, s48, s46
    s_add_u32 s46, s46, 22528
m_wo1:
    s_mov_b32 m0, s46
    s_add_u32 s46, s46, 1024
    buffer_load_dwordx4 v15, s[16:19], s48 offen sc1 lds
    s_add_u32 s48, s48, 1024
    s_sub_u32 s47, s47, 1
    s_cmp_lg_u32 s47, 0
    s_cbranch_scc1 m_wo1
    v_mov_b32 v4, 163760
    s_mov_b32 s75, 0
m_wr3:
    s_sleep 1
    ds_read_b128 v[8:11], v4
    s_add_u32 s75, s75, 1
    s_waitcnt lgkmcnt(0)
    s_cmp_ge_u32 s75, 2097152
    s_cbranch_scc1 m_wr3_ok
m_wr3_chk:
    v_min_u32 v8, v8, v10
    v_min_u32 v9, v9, v11
    v_min_u32 v8, v8, v9
    s_nop 0
    v_readfirstlane_b32 s43, v8
    s_cmp_lt_u32 s43, 1
    s_cbranch_scc1 m_wr3
m_wr3_ok:
    s_mul_i32 s46, s33, 21
    s_mov_b32 s47, 21
    s_lshl_b32 s43, s33, 4
    s_add_u32 s43, s43, 55
    s_cmp_ge_u32 s33, 2
    s_cselect_b32 s46, s43, s46
    s_cselect_b32 s47, 16, s47
    s_lshl_b32 s46, s46, 10
    s_mul_i32 s48, s36, 138240
    s_add_u32 s48, s48, s46
    s_add_u32 s46, s46, 22528
m_wo2:
    s_mov_b32 m0, s46
    s_add_u32 s46, s46, 1024
    buffer_load_dwordx4 v15, s[16:19], s48 offen sc1 lds
    s_add_u32 s48, s48, 1024
    s_sub_u32 s47, s47, 1
    s_cmp_lg_u32 s47, 0
    s_cbranch_scc1 m_wo2
    s_branch m_P3
m_gemm1:
    v_and_b32 v2, 15, v1
    v_lshrrev_b32 v3, 4, v1
    v_lshlrev_b32 v12, 4, v1
    v_add_u32 v13, 4096, v12
    v_mov_b32 v10, 0
    v_and_b32 v4, 31, v1
    v_lshlrev_b32 v4, 2, v4
    v_add_u32 v4, 163712, v4
    ds_write_b32 v4, v10
    s_waitcnt lgkmcnt(0)
    s_mov_b32 s64, s12
    s_mov_b32 s65, s13
    s_mov_b32 s66, 256
    s_mov_b32 s67, 0x00020000
    s_cmp_lg_u32 s2, 0
    s_cbranch_scc1 m_noep
    s_cmp_lg_u32 s32, 4
    s_cbranch_scc1 m_noep
    s_memrealtime s[44:45]
    s_waitcnt lgkmcnt(0)
    s_or_b32 s44, s44, 1
    v_mov_b32 v4, s44
    s_mov_b64 exec, 1
    buffer_store_dword v4, v10, s[64:67], 0 offen sc1
    s_mov_b64 exec, -1
m_noep:
    s_lshl_b32 s43, s35, 2
    s_add_u32 s43, s43, s33
    s_mul_i32 s72, s43, 7168
    s_lshl_b32 s44, s36, 9
    s_add_u32 s73, s72, s44
    s_lshl_b32 s74, s36, 6
    s_add_u32 s74, s74, s43
    s_lshl_b32 s74, s74, 2
    v_and_b32 v4, 7, v1
    v_lshl_add_u32 v4, v3, 3, v4
    v_bfe_u32 v5, v1, 3, 1
    v_lshlrev_b32 v5, 3, v5
    v_lshl_add_u32 v230, v4, 4, v5
    s_add_u32 s28, s14, 20971520
    s_addc_u32 s29, s15, 0
    s_mov_b32 s30, 458752
    s_mov_b32 s31, 0x00020000
    s_add_u32 s24, s14, 4194304
    s_addc_u32 s25, s15, 0
    s_mov_b32 s26, 3538944
    s_mov_b32 s27, 0x00020000
    s_add_u32 s20, s14, 8388608
    s_addc_u32 s21, s15, 0
    s_mov_b32 s22, 3538944
    s_mov_b32 s23, 0x00020000
    s_add_u32 s60, s14, 25165824
    s_addc_u32 s61, s15, 0
    s_mov_b32 s62, 262144
    s_mov_b32 s63, 0x00020000
    s_xor_b32 s43, s33, 0
    s_lshl_b32 s44, s36, 2
    s_add_u32 s43, s43, s44
    s_sub_u32 s43, s43, 2
    s_cmp_lt_u32 s43, 54
    s_cselect_b32 s50, -1, 0
    s_cselect_b32 s43, s43, 60
    s_lshl_b32 s46, s43, 16
    s_lshl_b32 s44, s35, 2
    s_add_u32 s44, s44, s33
    s_lshl_b32 s44, s44, 10
    s_add_u32 s46, s46, s44
    s_xor_b32 s43, s33, 1
    s_lshl_b32 s44, s36, 2
    s_add_u32 s43, s43, s44
    s_sub_u32 s43, s43, 2
    s_cmp_lt_u32 s43, 54
    s_cselect_b32 s51, -1, 0
    s_cselect_b32 s43, s43, 60
    s_lshl_b32 s47, s43, 16
    s_lshl_b32 s44, s35, 2
    s_add_u32 s44, s44, s33
    s_lshl_b32 s44, s44, 10
    s_add_u32 s47, s47, s44
    s_xor_b32 s43, s33, 2
    s_lshl_b32 s44, s36, 2
    s_add_u32 s43, s43, s44
    s_sub_u32 s43, s43, 2
    s_cmp_lt_u32 s43, 54
    s_cselect_b32 s52, -1, 0
    s_cselect_b32 s43, s43, 60
    s_lshl_b32 s48, s43, 16
    s_lshl_b32 s44, s35, 2
    s_add_u32 s44, s44, s33
    s_lshl_b32 s44, s44, 10
    s_add_u32 s48, s48, s44
    s_xor_b32 s43, s33, 3
    s_lshl_b32 s44, s36, 2
    s_add_u32 s43, s43, s44
    s_sub_u32 s43, s43, 2
    s_cmp_lt_u32 s43, 54
    s_cselect_b32 s53, -1, 0
    s_cselect_b32 s43, s43, 60
    s_lshl_b32 s49, s43, 16
    s_lshl_b32 s44, s35, 2
    s_add_u32 s44, s44, s33
    s_lshl_b32 s44, s44, 10
    s_add_u32 s49, s49, s44
    s_lshr_b32 s43, s33, 1
    s_xor_b32 s43, s43, 0
    s_lshl_b32 s44, s36, 1
    s_add_u32 s43, s43, s44
    s_lshl_b32 s44, s35, 3
    s_lshl_b32 s45, s33, 1
    s_add_u32 s44, s44, s45
    s_add_u32 s44, s44, 0
    s_mul_i32 s44, s44, 27
    s_add_u32 s44, s44, s43
    s_lshl_b32 s44, s44, 10
    s_cmp_lt_u32 s43, 27
    s_cselect_b32 s68, s44, 1073741824
    s_lshr_b32 s43, s33, 1
    s_xor_b32 s43, s43, 1
    s_lshl_b32 s44, s36, 1
    s_add_u32 s43, s43, s44
    s_lshl_b32 s44, s35, 3
    s_lshl_b32 s45, s33, 1
    s_add_u32 s44, s44, s45
    s_add_u32 s44, s44, 0
    s_mul_i32 s44, s44, 27
    s_add_u32 s44, s44, s43
    s_lshl_b32 s44, s44, 10
    s_cmp_lt_u32 s43, 27
    s_cselect_b32 s69, s44, 1073741824
    s_lshr_b32 s43, s33, 1
    s_xor_b32 s43, s43, 0
    s_lshl_b32 s44, s36, 1
    s_add_u32 s43, s43, s44
    s_lshl_b32 s44, s35, 3
    s_lshl_b32 s45, s33, 1
    s_add_u32 s44, s44, s45
    s_add_u32 s44, s44, 1
    s_mul_i32 s44, s44, 27
    s_add_u32 s44, s44, s43
    s_lshl_b32 s44, s44, 10
    s_cmp_lt_u32 s43, 27
    s_cselect_b32 s70, s44, 1073741824
    s_lshr_b32 s43, s33, 1
    s_xor_b32 s43, s43, 1
    s_lshl_b32 s44, s36, 1
    s_add_u32 s43, s43, s44
    s_lshl_b32 s44, s35, 3
    s_lshl_b32 s45, s33, 1
    s_add_u32 s44, s44, s45
    s_add_u32 s44, s44, 1
    s_mul_i32 s44, s44, 27
    s_add_u32 s44, s44, s43
    s_lshl_b32 s44, s44, 10
    s_cmp_lt_u32 s43, 27
    s_cselect_b32 s71, s44, 1073741824
    v_and_b32 v4, 2, v1
    v_and_b32 v5, 1, v1
    v_cmp_ne_u32 s[54:55], 0, v4
    v_cmp_ne_u32 s[56:57], 0, v5
    s_lshl_b32 s43, s33, 5
    v_add_u32 v4, s43, v2
    v_lshlrev_b32 v4, 7, v4
    v_lshrrev_b32 v5, 1, v2
    v_xor_b32 v5, v5, v3
    v_lshl_add_u32 v14, v5, 4, v4
    v_xor_b32 v15, 64, v14
    v_bfe_u32 v4, v1, 2, 2
    v_lshl_add_u32 v5, v3, 3, v4
    v_lshlrev_b32 v5, 7, v5
    v_and_b32 v6, 3, v1
    v_lshl_add_u32 v5, v6, 3, v5
    v_add_u32 v5, 16384, v5
    v_lshrrev_b32 v6, 1, v4
    v_and_b32 v7, 1, v3
    v_lshl_or_b32 v6, v7, 1, v6
    v_xor_b32 v6, s33, v6
    v_xor_b32 v7, 0, v6
    v_lshl_add_u32 v16, v7, 5, v5
    v_xor_b32 v7, 1, v6
    v_lshl_add_u32 v17, v7, 5, v5
    v_xor_b32 v7, 2, v6
    v_lshl_add_u32 v18, v7, 5, v5
    v_xor_b32 v7, 3, v6
    v_lshl_add_u32 v19, v7, 5, v5
    v_mov_b32 v20, 0x3f803f80
    v_mov_b32 v21, 0x3f803f80
    v_mov_b32 v22, 0x3f803f80
    v_mov_b32 v23, 0x3f803f80
    v_mov_b32 v104, 0
    v_mov_b32 v105, 0
    v_mov_b32 v106, 0
    v_mov_b32 v107, 0
    v_mov_b32 v108, 0
    v_mov_b32 v109, 0
    v_mov_b32 v110, 0
    v_mov_b32 v111, 0
    v_mov_b32 v112, 0
    v_mov_b32 v113, 0
    v_mov_b32 v114, 0
    v_mov_b32 v115, 0
    v_mov_b32 v116, 0
    v_mov_b32 v117, 0
    v_mov_b32 v118, 0
    v_mov_b32 v119, 0
    v_mov_b32 v120, 0
    v_mov_b32 v121, 0
    v_mov_b32 v122, 0
    v_mov_b32 v123, 0
    v_mov_b32 v124, 0
    v_mov_b32 v125, 0
    v_mov_b32 v126, 0
    v_mov_b32 v127, 0
    v_mov_b32 v128, 0
    v_mov_b32 v129, 0
    v_mov_b32 v130, 0
    v_mov_b32 v131, 0
    v_mov_b32 v132, 0
    v_mov_b32 v133, 0
    v_mov_b32 v134, 0
    v_mov_b32 v135, 0
    v_mov_b32 v136, 0
    v_mov_b32 v137, 0
    v_mov_b32 v138, 0
    v_mov_b32 v139, 0
    v_mov_b32 v140, 0
    v_mov_b32 v141, 0
    v_mov_b32 v142, 0
    v_mov_b32 v143, 0
    v_mov_b32 v144, 0
    v_mov_b32 v145, 0
    v_mov_b32 v146, 0
    v_mov_b32 v147, 0
    v_mov_b32 v148, 0
    v_mov_b32 v149, 0
    v_mov_b32 v150, 0
    v_mov_b32 v151, 0
    v_mov_b32 v152, 0
    v_mov_b32 v153, 0
    v_mov_b32 v154, 0
    v_mov_b32 v155, 0
    v_mov_b32 v156, 0
    v_mov_b32 v157, 0
    v_mov_b32 v158, 0
    v_mov_b32 v159, 0
    v_mov_b32 v160, 0
    v_mov_b32 v161, 0
    v_mov_b32 v162, 0
    v_mov_b32 v163, 0
    v_mov_b32 v164, 0
    v_mov_b32 v165, 0
    v_mov_b32 v166, 0
    v_mov_b32 v167, 0
    v_mov_b32 v168, 0
    v_mov_b32 v169, 0
    v_mov_b32 v170, 0
    v_mov_b32 v171, 0
    v_mov_b32 v172, 0
    v_mov_b32 v173, 0
    v_mov_b32 v174, 0
    v_mov_b32 v175, 0
    v_mov_b32 v176, 0
    v_mov_b32 v177, 0
    v_mov_b32 v178, 0
    v_mov_b32 v179, 0
    v_mov_b32 v180, 0
    v_mov_b32 v181, 0
    v_mov_b32 v182, 0
    v_mov_b32 v183, 0
    v_mov_b32 v184, 0
    v_mov_b32 v185, 0
    v_mov_b32 v186, 0
    v_mov_b32 v187, 0
    v_mov_b32 v188, 0
    v_mov_b32 v189, 0
    v_mov_b32 v190, 0
    v_mov_b32 v191, 0
    s_lshl_b32 s43, s33, 6
    s_add_u32 s43, s43, 162176
    v_lshl_add_u32 v196, v2, 2, s43
    s_xor_b32 s43, s33, 0
    s_lshl_b32 s43, s43, 6
    s_add_u32 s43, s43, 162176
    v_lshl_add_u32 v232, v2, 2, s43
    v_lshl_add_u32 v236, v3, 4, s43
    s_xor_b32 s43, s33, 1
    s_lshl_b32 s43, s43, 6
    s_add_u32 s43, s43, 162176
    v_lshl_add_u32 v233, v2, 2, s43
    v_lshl_add_u32 v237, v3, 4, s43
    s_xor_b32 s43, s33, 2
    s_lshl_b32 s43, s43, 6
    s_add_u32 s43, s43, 162176
    v_lshl_add_u32 v234, v2, 2, s43
    v_lshl_add_u32 v238, v3, 4, s43
    s_xor_b32 s43, s33, 3
    s_lshl_b32 s43, s43, 6
    s_add_u32 s43, s43, 162176
    v_lshl_add_u32 v235, v2, 2, s43
    v_lshl_add_u32 v239, v3, 4, s43
    s_lshl_b32 s43, s33, 7
    s_add_u32 s43, s43, 161152
    v_lshl_add_u32 v7, v2, 2, s43
    v_lshl_add_u32 v8, v3, 4, s43
    v_mov_b32 v9, 163712
    s_mov_b32 s40, 10
    s_barrier
    ds_read_b128 v[24:27], v14 offset:0
    ds_read_b128 v[28:31], v14 offset:2048
    ds_read_b64_tr_b16 v[32:33], v16 offset:0
    ds_read_b64_tr_b16 v[34:35], v16 offset:512
    ds_read_b64_tr_b16 v[36:37], v17 offset:0
    ds_read_b64_tr_b16 v[38:39], v17 offset:512
    ds_read_b64_tr_b16 v[40:41], v18 offset:0
    ds_read_b64_tr_b16 v[42:43], v18 offset:512
    ds_read_b64_tr_b16 v[44:45], v19 offset:0
    ds_read_b64_tr_b16 v[46:47], v19 offset:512
    ds_read_b64_tr_b16 v[48:49], v16 offset:8192
    ds_read_b64_tr_b16 v[50:51], v16 offset:8704
    ds_read_b64_tr_b16 v[52:53], v17 offset:8192
    ds_read_b64_tr_b16 v[54:55], v17 offset:8704
    ds_read_b64_tr_b16 v[56:57], v18 offset:8192
    ds_read_b64_tr_b16 v[58:59], v18 offset:8704
    ds_read_b64_tr_b16 v[60:61], v19 offset:8192
    ds_read_b64_tr_b16 v[62:63], v19 offset:8704
m_loop1:
    s_waitcnt lgkmcnt(0)
    v_mfma_f32_16x16x32_bf16 v[184:187], v[20:23], v[32:35], v[184:187]
    ds_read_b128 v[64:67], v15 offset:0
    ds_read_b128 v[68:71], v15 offset:2048
    v_mfma_f32_16x16x32_bf16 v[104:107], v[24:27], v[32:35], v[104:107]
    ds_read_b64_tr_b16 v[72:73], v16 offset:4096
    ds_read_b64_tr_b16 v[74:75], v16 offset:4608
    v_mfma_f32_16x16x32_bf16 v[120:123], v[28:31], v[32:35], v[120:123]
    ds_read_b64_tr_b16 v[76:77], v17 offset:4096
    ds_read_b64_tr_b16 v[78:79], v17 offset:4608
    v_mfma_f32_16x16x32_bf16 v[108:111], v[24:27], v[36:39], v[108:111]
    ds_read_b64_tr_b16 v[80:81], v18 offset:4096
    ds_read_b64_tr_b16 v[82:83], v18 offset:4608
    v_mfma_f32_16x16x32_bf16 v[124:127], v[28:31], v[36:39], v[124:127]
    ds_read_b64_tr_b16 v[84:85], v19 offset:4096
    v_mfma_f32_16x16x32_bf16 v[112:115], v[24:27], v[40:43], v[112:115]
    ds_read_b64_tr_b16 v[86:87], v19 offset:4608
    v_mfma_f32_16x16x32_bf16 v[128:131], v[28:31], v[40:43], v[128:131]
    ds_read_b64_tr_b16 v[88:89], v16 offset:12288
    v_mfma_f32_16x16x32_bf16 v[116:119], v[24:27], v[44:47], v[116:119]
    ds_read_b64_tr_b16 v[90:91], v16 offset:12800
    v_mfma_f32_16x16x32_bf16 v[132:135], v[28:31], v[44:47], v[132:135]
    ds_read_b64_tr_b16 v[92:93], v17 offset:12288
    v_mfma_f32_16x16x32_bf16 v[188:191], v[20:23], v[48:51], v[188:191]
    ds_read_b64_tr_b16 v[94:95], v17 offset:12800
    v_mfma_f32_16x16x32_bf16 v[136:139], v[48:51], v[24:27], v[136:139]
    ds_read_b64_tr_b16 v[96:97], v18 offset:12288
    v_mfma_f32_16x16x32_bf16 v[152:155], v[48:51], v[28:31], v[152:155]
    ds_read_b64_tr_b16 v[98:99], v18 offset:12800
    v_mfma_f32_16x16x32_bf16 v[140:143], v[52:55], v[24:27], v[140:143]
    ds_read_b64_tr_b16 v[100:101], v19 offset:12288
    v_mfma_f32_16x16x32_bf16 v[156:159], v[52:55], v[28:31], v[156:159]
    ds_read_b64_tr_b16 v[102:103], v19 offset:12800
    v_add_u32 v14, 0x8000, v14
    v_add_u32 v15, 0x8000, v15
    v_add_u32 v16, 0x8000, v16
    v_mfma_f32_16x16x32_bf16 v[144:147], v[56:59], v[24:27], v[144:147]
    v_add_u32 v17, 0x8000, v17
    v_add_u32 v18, 0x8000, v18
    v_add_u32 v19, 0x8000, v19
    v_mfma_f32_16x16x32_bf16 v[160:163], v[56:59], v[28:31], v[160:163]
    v_and_b32 v14, 0x1ffff, v14
    v_and_b32 v15, 0x1ffff, v15
    v_and_b32 v16, 0x1ffff, v16
    v_mfma_f32_16x16x32_bf16 v[148:151], v[60:63], v[24:27], v[148:151]
    v_and_b32 v17, 0x1ffff, v17
    v_and_b32 v18, 0x1ffff, v18
    v_and_b32 v19, 0x1ffff, v19
    v_mfma_f32_16x16x32_bf16 v[164:167], v[60:63], v[28:31], v[164:167]
    s_sub_u32 s40, s40, 1
    s_cmp_eq_u32 s40, 0
    s_waitcnt lgkmcnt(0)
    s_cbranch_scc1 m_tail1
    s_barrier
    v_mfma_f32_16x16x32_bf16 v[184:187], v[20:23], v[72:75], v[184:187]
    ds_read_b128 v[24:27], v14 offset:0
    ds_read_b128 v[28:31], v14 offset:2048
    v_mfma_f32_16x16x32_bf16 v[104:107], v[64:67], v[72:75], v[104:107]
    ds_read_b64_tr_b16 v[32:33], v16 offset:0
    ds_read_b64_tr_b16 v[34:35], v16 offset:512
    v_mfma_f32_16x16x32_bf16 v[120:123], v[68:71], v[72:75], v[120:123]
    ds_read_b64_tr_b16 v[36:37], v17 offset:0
    ds_read_b64_tr_b16 v[38:39], v17 offset:512
    v_mfma_f32_16x16x32_bf16 v[108:111], v[64:67], v[76:79], v[108:111]
    ds_read_b64_tr_b16 v[40:41], v18 offset:0
    ds_read_b64_tr_b16 v[42:43], v18 offset:512
    v_mfma_f32_16x16x32_bf16 v[124:127], v[68:71], v[76:79], v[124:127]
    ds_read_b64_tr_b16 v[44:45], v19 offset:0
    v_mfma_f32_16x16x32_bf16 v[112:115], v[64:67], v[80:83], v[112:115]
    ds_read_b64_tr_b16 v[46:47], v19 offset:512
    v_mfma_f32_16x16x32_bf16 v[128:131], v[68:71], v[80:83], v[128:131]
    ds_read_b64_tr_b16 v[48:49], v16 offset:8192
    v_mfma_f32_16x16x32_bf16 v[116:119], v[64:67], v[84:87], v[116:119]
    ds_read_b64_tr_b16 v[50:51], v16 offset:8704
    v_mfma_f32_16x16x32_bf16 v[132:135], v[68:71], v[84:87], v[132:135]
    ds_read_b64_tr_b16 v[52:53], v17 offset:8192
    v_mfma_f32_16x16x32_bf16 v[188:191], v[20:23], v[88:91], v[188:191]
    ds_read_b64_tr_b16 v[54:55], v17 offset:8704
    v_mfma_f32_16x16x32_bf16 v[136:139], v[88:91], v[64:67], v[136:139]
    ds_read_b64_tr_b16 v[56:57], v18 offset:8192
    v_mfma_f32_16x16x32_bf16 v[152:155], v[88:91], v[68:71], v[152:155]
    ds_read_b64_tr_b16 v[58:59], v18 offset:8704
    v_mfma_f32_16x16x32_bf16 v[140:143], v[92:95], v[64:67], v[140:143]
    ds_read_b64_tr_b16 v[60:61], v19 offset:8192
    v_mfma_f32_16x16x32_bf16 v[156:159], v[92:95], v[68:71], v[156:159]
    ds_read_b64_tr_b16 v[62:63], v19 offset:8704
    v_mfma_f32_16x16x32_bf16 v[144:147], v[96:99], v[64:67], v[144:147]
    v_mfma_f32_16x16x32_bf16 v[160:163], v[96:99], v[68:71], v[160:163]
    v_mfma_f32_16x16x32_bf16 v[148:151], v[100:103], v[64:67], v[148:151]
    v_mfma_f32_16x16x32_bf16 v[164:167], v[100:103], v[68:71], v[164:167]
    s_branch m_loop1
m_tail1:
    v_mfma_f32_16x16x32_bf16 v[184:187], v[20:23], v[72:75], v[184:187]
    v_mfma_f32_16x16x32_bf16 v[104:107], v[64:67], v[72:75], v[104:107]
    v_mfma_f32_16x16x32_bf16 v[120:123], v[68:71], v[72:75], v[120:123]
    v_mfma_f32_16x16x32_bf16 v[108:111], v[64:67], v[76:79], v[108:111]
    v_mfma_f32_16x16x32_bf16 v[124:127], v[68:71], v[76:79], v[124:127]
    v_mfma_f32_16x16x32_bf16 v[112:115], v[64:67], v[80:83], v[112:115]
    v_mfma_f32_16x16x32_bf16 v[128:131], v[68:71], v[80:83], v[128:131]
    v_mfma_f32_16x16x32_bf16 v[116:119], v[64:67], v[84:87], v[116:119]
    v_mfma_f32_16x16x32_bf16 v[132:135], v[68:71], v[84:87], v[132:135]
    v_mfma_f32_16x16x32_bf16 v[188:191], v[20:23], v[88:91], v[188:191]
    v_mfma_f32_16x16x32_bf16 v[136:139], v[88:91], v[64:67], v[136:139]
    v_mfma_f32_16x16x32_bf16 v[152:155], v[88:91], v[68:71], v[152:155]
    v_mfma_f32_16x16x32_bf16 v[140:143], v[92:95], v[64:67], v[140:143]
    v_mfma_f32_16x16x32_bf16 v[156:159], v[92:95], v[68:71], v[156:159]
    v_mfma_f32_16x16x32_bf16 v[144:147], v[96:99], v[64:67], v[144:147]
    v_mfma_f32_16x16x32_bf16 v[160:163], v[96:99], v[68:71], v[160:163]
    v_mfma_f32_16x16x32_bf16 v[148:151], v[100:103], v[64:67], v[148:151]
    v_mfma_f32_16x16x32_bf16 v[164:167], v[100:103], v[68:71], v[164:167]
    s_setprio 2
    ds_write_b32 v196, v184
    ds_write_b32 v196, v188 offset:256
    s_waitcnt lgkmcnt(0)
    s_barrier
    ds_read_b128 v[24:27], v8
    ds_read_b128 v[28:31], v8 offset:64
    ds_read_b128 v[32:35], v8 offset:512
    ds_read_b128 v[36:39], v8 offset:576
    ds_read_b32 v40, v232
    ds_read_b32 v42, v233
    ds_read_b32 v44, v234
    ds_read_b32 v46, v235
    ds_read_b32 v229, v9
    ds_read_b128 v[64:67], v236 offset:256
    ds_read_b128 v[68:71], v237 offset:256
    ds_read_b128 v[72:75], v238 offset:256
    ds_read_b128 v[76:79], v239 offset:256
    ds_read_b32 v80, v7
    ds_read_b32 v82, v7 offset:64
    ds_read_b32 v84, v7 offset:512
    ds_read_b32 v86, v7 offset:576
    v_mov_b32 v88, 0xbdd2d3e8
    v_mov_b32 v90, 0xc0135761
    s_waitcnt lgkmcnt(8)
    v_readfirstlane_b32 s3, v229
    s_cmp_lg_u32 s36, 0
    s_cbranch_scc1 m_nomask
    v_and_b32 v40, s50, v40
    v_and_b32 v104, s50, v104
    v_and_b32 v105, s50, v105
    v_and_b32 v106, s50, v106
    v_and_b32 v107, s50, v107
    v_and_b32 v120, s50, v120
    v_and_b32 v121, s50, v121
    v_and_b32 v122, s50, v122
    v_and_b32 v123, s50, v123
    v_and_b32 v42, s51, v42
    v_and_b32 v108, s51, v108
    v_and_b32 v109, s51, v109
    v_and_b32 v110, s51, v110
    v_and_b32 v111, s51, v111
    v_and_b32 v124, s51, v124
    v_and_b32 v125, s51, v125
    v_and_b32 v126, s51, v126
    v_and_b32 v127, s51, v127
    v_and_b32 v44, s52, v44
    v_and_b32 v112, s52, v112
    v_and_b32 v113, s52, v113
    v_and_b32 v114, s52, v114
    v_and_b32 v115, s52, v115
    v_and_b32 v128, s52, v128
    v_and_b32 v129, s52, v129
    v_and_b32 v130, s52, v130
    v_and_b32 v131, s52, v131
    v_and_b32 v46, s53, v46
    v_and_b32 v116, s53, v116
    v_and_b32 v117, s53, v117
    v_and_b32 v118, s53, v118
    v_and_b32 v119, s53, v119
    v_and_b32 v132, s53, v132
    v_and_b32 v133, s53, v133
    v_and_b32 v134, s53, v134
    v_and_b32 v135, s53, v135
m_nomask:
    v_pk_fma_f32 v[104:105], v[24:25], v[40:41], v[104:105] op_sel_hi:[1,0,1] neg_lo:[1,0,0] neg_hi:[1,0,0]
    v_pk_fma_f32 v[106:107], v[26:27], v[40:41], v[106:107] op_sel_hi:[1,0,1] neg_lo:[1,0,0] neg_hi:[1,0,0]
    v_pk_fma_f32 v[120:121], v[28:29], v[40:41], v[120:121] op_sel_hi:[1,0,1] neg_lo:[1,0,0] neg_hi:[1,0,0]
    v_pk_fma_f32 v[122:123], v[30:31], v[40:41], v[122:123] op_sel_hi:[1,0,1] neg_lo:[1,0,0] neg_hi:[1,0,0]
    v_pk_fma_f32 v[108:109], v[24:25], v[42:43], v[108:109] op_sel_hi:[1,0,1] neg_lo:[1,0,0] neg_hi:[1,0,0]
    v_pk_fma_f32 v[110:111], v[26:27], v[42:43], v[110:111] op_sel_hi:[1,0,1] neg_lo:[1,0,0] neg_hi:[1,0,0]
    v_pk_fma_f32 v[124:125], v[28:29], v[42:43], v[124:125] op_sel_hi:[1,0,1] neg_lo:[1,0,0] neg_hi:[1,0,0]
    v_pk_fma_f32 v[126:127], v[30:31], v[42:43], v[126:127] op_sel_hi:[1,0,1] neg_lo:[1,0,0] neg_hi:[1,0,0]
    v_pk_mul_f32 v[104:105], v[104:105], v[32:33]
    v_pk_mul_f32 v[106:107], v[106:107], v[34:35]
    v_pk_mul_f32 v[120:121], v[120:121], v[36:37]
    v_pk_mul_f32 v[122:123], v[122:123], v[38:39]
    v_pk_mul_f32 v[108:109], v[108:109], v[32:33]
    v_pk_mul_f32 v[110:111], v[110:111], v[34:35]
    v_pk_mul_f32 v[124:125], v[124:125], v[36:37]
    v_pk_mul_f32 v[126:127], v[126:127], v[38:39]
    v_pk_mul_f32 v[48:49], v[104:105], v[104:105]
    v_pk_mul_f32 v[50:51], v[106:107], v[106:107]
    v_pk_mul_f32 v[52:53], v[120:121], v[120:121]
    v_pk_mul_f32 v[54:55], v[122:123], v[122:123]
    v_pk_mul_f32 v[56:57], v[108:109], v[108:109]
    v_pk_mul_f32 v[58:59], v[110:111], v[110:111]
    v_pk_mul_f32 v[60:61], v[124:125], v[124:125]
    v_pk_mul_f32 v[62:63], v[126:127], v[126:127]
    v_pk_fma_f32 v[48:49], v[48:49], v[88:89], v[90:91] op_sel_hi:[1,0,0]
    v_pk_fma_f32 v[50:51], v[50:51], v[88:89], v[90:91] op_sel_hi:[1,0,0]
    v_pk_fma_f32 v[52:53], v[52:53], v[88:89], v[90:91] op_sel_hi:[1,0,0]
    v_pk_fma_f32 v[54:55], v[54:55], v[88:89], v[90:91] op_sel_hi:[1,0,0]
    v_pk_fma_f32 v[56:57], v[56:57], v[88:89], v[90:91] op_sel_hi:[1,0,0]
    v_pk_fma_f32 v[58:59], v[58:59], v[88:89], v[90:91] op_sel_hi:[1,0,0]
    v_pk_fma_f32 v[60:61], v[60:61], v[88:89], v[90:91] op_sel_hi:[1,0,0]
    v_pk_fma_f32 v[62:63], v[62:63], v[88:89], v[90:91] op_sel_hi:[1,0,0]
    v_pk_mul_f32 v[48:49], v[48:49], v[104:105]
    v_pk_mul_f32 v[50:51], v[50:51], v[106:107]
    v_pk_mul_f32 v[52:53], v[52:53], v[120:121]
    v_pk_mul_f32 v[54:55], v[54:55], v[122:123]
    v_pk_mul_f32 v[56:57], v[56:57], v[108:109]
    v_pk_mul_f32 v[58:59], v[58:59], v[110:111]
    v_pk_mul_f32 v[60:61], v[60:61], v[124:125]
    v_pk_mul_f32 v[62:63], v[62:63], v[126:127]
    v_exp_f32 v48, v48
    v_exp_f32 v49, v49
    v_exp_f32 v50, v50
    v_exp_f32 v51, v51
    v_exp_f32 v52, v52
    v_exp_f32 v53, v53
    v_exp_f32 v54, v54
    v_exp_f32 v55, v55
    v_exp_f32 v56, v56
    v_exp_f32 v57, v57
    v_exp_f32 v58, v58
    v_exp_f32 v59, v59
    v_exp_f32 v60, v60
    v_exp_f32 v61, v61
    v_exp_f32 v62, v62
    v_exp_f32 v63, v63
    v_pk_add_f32 v[48:49], v[48:49], 1.0 op_sel_hi:[1,0]
    v_pk_add_f32 v[50:51], v[50:51], 1.0 op_sel_hi:[1,0]
    v_pk_add_f32 v[52:53], v[52:53], 1.0 op_sel_hi:[1,0]
    v_pk_add_f32 v[54:55], v[54:55], 1.0 op_sel_hi:[1,0]
    v_pk_add_f32 v[56:57], v[56:57], 1.0 op_sel_hi:[1,0]
    v_pk_add_f32 v[58:59], v[58:59], 1.0 op_sel_hi:[1,0]
    v_pk_add_f32 v[60:61], v[60:61], 1.0 op_sel_hi:[1,0]
    v_pk_add_f32 v[62:63], v[62:63], 1.0 op_sel_hi:[1,0]
    v_rcp_f32 v48, v48
    v_rcp_f32 v49, v49
    v_rcp_f32 v50, v50
    v_rcp_f32 v51, v51
    v_rcp_f32 v52, v52
    v_rcp_f32 v53, v53
    v_rcp_f32 v54, v54
    v_rcp_f32 v55, v55
    v_rcp_f32 v56, v56
    v_rcp_f32 v57, v57
    v_rcp_f32 v58, v58
    v_rcp_f32 v59, v59
    v_rcp_f32 v60, v60
    v_rcp_f32 v61, v61
    v_rcp_f32 v62, v62
    v_rcp_f32 v63, v63
    v_pk_mul_f32 v[104:105], v[104:105], v[48:49]
    v_pk_mul_f32 v[106:107], v[106:107], v[50:51]
    v_pk_mul_f32 v[120:121], v[120:121], v[52:53]
    v_pk_mul_f32 v[122:123], v[122:123], v[54:55]
    v_pk_mul_f32 v[108:109], v[108:109], v[56:57]
    v_pk_mul_f32 v[110:111], v[110:111], v[58:59]
    v_pk_mul_f32 v[124:125], v[124:125], v[60:61]
    v_pk_mul_f32 v[126:127], v[126:127], v[62:63]
    v_pk_add_f32 v[168:169], v[168:169], v[104:105]
    v_pk_fma_f32 v[176:177], v[104:105], v[104:105], v[176:177]
    v_pk_add_f32 v[170:171], v[170:171], v[106:107]
    v_pk_fma_f32 v[178:179], v[106:107], v[106:107], v[178:179]
    v_pk_add_f32 v[172:173], v[172:173], v[120:121]
    v_pk_fma_f32 v[180:181], v[120:121], v[120:121], v[180:181]
    v_pk_add_f32 v[174:175], v[174:175], v[122:123]
    v_pk_fma_f32 v[182:183], v[122:123], v[122:123], v[182:183]
    v_pk_add_f32 v[168:169], v[168:169], v[108:109]
    v_pk_fma_f32 v[176:177], v[108:109], v[108:109], v[176:177]
    v_pk_add_f32 v[170:171], v[170:171], v[110:111]
    v_pk_fma_f32 v[178:179], v[110:111], v[110:111], v[178:179]
    v_pk_add_f32 v[172:173], v[172:173], v[124:125]
    v_pk_fma_f32 v[180:181], v[124:125], v[124:125], v[180:181]
    v_pk_add_f32 v[174:175], v[174:175], v[126:127]
    v_pk_fma_f32 v[182:183], v[126:127], v[126:127], v[182:183]
    v_pk_fma_f32 v[112:113], v[24:25], v[44:45], v[112:113] op_sel_hi:[1,0,1] neg_lo:[1,0,0] neg_hi:[1,0,0]
    v_pk_fma_f32 v[114:115], v[26:27], v[44:45], v[114:115] op_sel_hi:[1,0,1] neg_lo:[1,0,0] neg_hi:[1,0,0]
    v_pk_fma_f32 v[128:129], v[28:29], v[44:45], v[128:129] op_sel_hi:[1,0,1] neg_lo:[1,0,0] neg_hi:[1,0,0]
    v_pk_fma_f32 v[130:131], v[30:31], v[44:45], v[130:131] op_sel_hi:[1,0,1] neg_lo:[1,0,0] neg_hi:[1,0,0]
    v_pk_fma_f32 v[116:117], v[24:25], v[46:47], v[116:117] op_sel_hi:[1,0,1] neg_lo:[1,0,0] neg_hi:[1,0,0]
    v_pk_fma_f32 v[118:119], v[26:27], v[46:47], v[118:119] op_sel_hi:[1,0,1] neg_lo:[1,0,0] neg_hi:[1,0,0]
    v_pk_fma_f32 v[132:133], v[28:29], v[46:47], v[132:133] op_sel_hi:[1,0,1] neg_lo:[1,0,0] neg_hi:[1,0,0]
    v_pk_fma_f32 v[134:135], v[30:31], v[46:47], v[134:135] op_sel_hi:[1,0,1] neg_lo:[1,0,0] neg_hi:[1,0,0]
    v_pk_mul_f32 v[112:113], v[112:113], v[32:33]
    v_pk_mul_f32 v[114:115], v[114:115], v[34:35]
    v_pk_mul_f32 v[128:129], v[128:129], v[36:37]
    v_pk_mul_f32 v[130:131], v[130:131], v[38:39]
    v_pk_mul_f32 v[116:117], v[116:117], v[32:33]
    v_pk_mul_f32 v[118:119], v[118:119], v[34:35]
    v_pk_mul_f32 v[132:133], v[132:133], v[36:37]
    v_pk_mul_f32 v[134:135], v[134:135], v[38:39]
    v_pk_mul_f32 v[48:49], v[112:113], v[112:113]
    v_pk_mul_f32 v[50:51], v[114:115], v[114:115]
    v_pk_mul_f32 v[52:53], v[128:129], v[128:129]
    v_pk_mul_f32 v[54:55], v[130:131], v[130:131]
    v_pk_mul_f32 v[56:57], v[116:117], v[116:117]
    v_pk_mul_f32 v[58:59], v[118:119], v[118:119]
    v_pk_mul_f32 v[60:61], v[132:133], v[132:133]
    v_pk_mul_f32 v[62:63], v[134:135], v[134:135]
    v_pk_fma_f32 v[48:49], v[48:49], v[88:89], v[90:91] op_sel_hi:[1,0,0]
    v_pk_fma_f32 v[50:51], v[50:51], v[88:89], v[90:91] op_sel_hi:[1,0,0]
    v_pk_fma_f32 v[52:53], v[52:53], v[88:89], v[90:91] op_sel_hi:[1,0,0]
    v_pk_fma_f32 v[54:55], v[54:55], v[88:89], v[90:91] op_sel_hi:[1,0,0]
    v_pk_fma_f32 v[56:57], v[56:57], v[88:89], v[90:91] op_sel_hi:[1,0,0]
    v_pk_fma_f32 v[58:59], v[58:59], v[88:89], v[90:91] op_sel_hi:[1,0,0]
    v_pk_fma_f32 v[60:61], v[60:61], v[88:89], v[90:91] op_sel_hi:[1,0,0]
    v_pk_fma_f32 v[62:63], v[62:63], v[88:89], v[90:91] op_sel_hi:[1,0,0]
    v_pk_mul_f32 v[48:49], v[48:49], v[112:113]
    v_pk_mul_f32 v[50:51], v[50:51], v[114:115]
    v_pk_mul_f32 v[52:53], v[52:53], v[128:129]
    v_pk_mul_f32 v[54:55], v[54:55], v[130:131]
    v_pk_mul_f32 v[56:57], v[56:57], v[116:117]
    v_pk_mul_f32 v[58:59], v[58:59], v[118:119]
    v_pk_mul_f32 v[60:61], v[60:61], v[132:133]
    v_pk_mul_f32 v[62:63], v[62:63], v[134:135]
    v_exp_f32 v48, v48
    v_exp_f32 v49, v49
    v_exp_f32 v50, v50
    v_exp_f32 v51, v51
    v_exp_f32 v52, v52
    v_exp_f32 v53, v53
    v_exp_f32 v54, v54
    v_exp_f32 v55, v55
    v_exp_f32 v56, v56
    v_exp_f32 v57, v57
    v_exp_f32 v58, v58
    v_exp_f32 v59, v59
    v_exp_f32 v60, v60
    v_exp_f32 v61, v61
    v_exp_f32 v62, v62
    v_exp_f32 v63, v63
    v_pk_add_f32 v[48:49], v[48:49], 1.0 op_sel_hi:[1,0]
    v_pk_add_f32 v[50:51], v[50:51], 1.0 op_sel_hi:[1,0]
    v_pk_add_f32 v[52:53], v[52:53], 1.0 op_sel_hi:[1,0]
    v_pk_add_f32 v[54:55], v[54:55], 1.0 op_sel_hi:[1,0]
    v_pk_add_f32 v[56:57], v[56:57], 1.0 op_sel_hi:[1,0]
    v_pk_add_f32 v[58:59], v[58:59], 1.0 op_sel_hi:[1,0]
    v_pk_add_f32 v[60:61], v[60:61], 1.0 op_sel_hi:[1,0]
    v_pk_add_f32 v[62:63], v[62:63], 1.0 op_sel_hi:[1,0]
    v_rcp_f32 v48, v48
    v_rcp_f32 v49, v49
    v_rcp_f32 v50, v50
    v_rcp_f32 v51, v51
    v_rcp_f32 v52, v52
    v_rcp_f32 v53, v53
    v_rcp_f32 v54, v54
    v_rcp_f32 v55, v55
    v_rcp_f32 v56, v56
    v_rcp_f32 v57, v57
    v_rcp_f32 v58, v58
    v_rcp_f32 v59, v59
    v_rcp_f32 v60, v60
    v_rcp_f32 v61, v61
    v_rcp_f32 v62, v62
    v_rcp_f32 v63, v63
    v_pk_mul_f32 v[112:113], v[112:113], v[48:49]
    v_pk_mul_f32 v[114:115], v[114:115], v[50:51]
    v_pk_mul_f32 v[128:129], v[128:129], v[52:53]
    v_pk_mul_f32 v[130:131], v[130:131], v[54:55]
    v_pk_mul_f32 v[116:117], v[116:117], v[56:57]
    v_pk_mul_f32 v[118:119], v[118:119], v[58:59]
    v_pk_mul_f32 v[132:133], v[132:133], v[60:61]
    v_pk_mul_f32 v[134:135], v[134:135], v[62:63]
    v_pk_add_f32 v[168:169], v[168:169], v[112:113]
    v_pk_fma_f32 v[176:177], v[112:113], v[112:113], v[176:177]
    v_pk_add_f32 v[170:171], v[170:171], v[114:115]
    v_pk_fma_f32 v[178:179], v[114:115], v[114:115], v[178:179]
    v_pk_add_f32 v[172:173], v[172:173], v[128:129]
    v_pk_fma_f32 v[180:181], v[128:129], v[128:129], v[180:181]
    v_pk_add_f32 v[174:175], v[174:175], v[130:131]
    v_pk_fma_f32 v[182:183], v[130:131], v[130:131], v[182:183]
    v_pk_add_f32 v[168:169], v[168:169], v[116:117]
    v_pk_fma_f32 v[176:177], v[116:117], v[116:117], v[176:177]
    v_pk_add_f32 v[170:171], v[170:171], v[118:119]
    v_pk_fma_f32 v[178:179], v[118:119], v[118:119], v[178:179]
    v_pk_add_f32 v[172:173], v[172:173], v[132:133]
    v_pk_fma_f32 v[180:181], v[132:133], v[132:133], v[180:181]
    v_pk_add_f32 v[174:175], v[174:175], v[134:135]
    v_pk_fma_f32 v[182:183], v[134:135], v[134:135], v[182:183]
    s_nop 0
    v_add_f32_dpp v48, v168, v168 row_ror:8 row_mask:0xf bank_mask:0x3
    v_add_f32_dpp v49, v169, v169 row_ror:8 row_mask:0xf bank_mask:0x3
    v_add_f32_dpp v50, v170, v170 row_ror:8 row_mask:0xf bank_mask:0x3
    v_add_f32_dpp v51, v171, v171 row_ror:8 row_mask:0xf bank_mask:0x3
    v_add_f32_dpp v52, v172, v172 row_ror:8 row_mask:0xf bank_mask:0x3
    v_add_f32_dpp v53, v173, v173 row_ror:8 row_mask:0xf bank_mask:0x3
    v_add_f32_dpp v54, v174, v174 row_ror:8 row_mask:0xf bank_mask:0x3
    v_add_f32_dpp v55, v175, v175 row_ror:8 row_mask:0xf bank_mask:0x3
    v_add_f32_dpp v48, v176, v176 row_ror:8 row_mask:0xf bank_mask:0xc
    v_add_f32_dpp v49, v177, v177 row_ror:8 row_mask:0xf bank_mask:0xc
    v_add_f32_dpp v50, v178, v178 row_ror:8 row_mask:0xf bank_mask:0xc
    v_add_f32_dpp v51, v179, v179 row_ror:8 row_mask:0xf bank_mask:0xc
    v_add_f32_dpp v52, v180, v180 row_ror:8 row_mask:0xf bank_mask:0xc
    v_add_f32_dpp v53, v181, v181 row_ror:8 row_mask:0xf bank_mask:0xc
    v_add_f32_dpp v54, v182, v182 row_ror:8 row_mask:0xf bank_mask:0xc
    v_add_f32_dpp v55, v183, v183 row_ror:8 row_mask:0xf bank_mask:0xc
    v_add_f32_dpp v168, v48, v48 row_half_mirror row_mask:0xf bank_mask:0x5
    v_add_f32_dpp v169, v49, v49 row_half_mirror row_mask:0xf bank_mask:0x5
    v_add_f32_dpp v170, v50, v50 row_half_mirror row_mask:0xf bank_mask:0x5
    v_add_f32_dpp v171, v51, v51 row_half_mirror row_mask:0xf bank_mask:0x5
    v_add_f32_dpp v168, v52, v52 row_half_mirror row_mask:0xf bank_mask:0xa
    v_add_f32_dpp v169, v53, v53 row_half_mirror row_mask:0xf bank_mask:0xa
    v_add_f32_dpp v170, v54, v54 row_half_mirror row_mask:0xf bank_mask:0xa
    v_add_f32_dpp v171, v55, v55 row_half_mirror row_mask:0xf bank_mask:0xa
    v_cndmask_b32 v172, v170, v168, s[54:55]
    v_cndmask_b32 v174, v168, v170, s[54:55]
    v_cndmask_b32 v173, v171, v169, s[54:55]
    v_cndmask_b32 v175, v169, v171, s[54:55]
    s_nop 0
    v_add_f32_dpp v176, v172, v174 quad_perm:[2,3,0,1] row_mask:0xf bank_mask:0xf
    v_add_f32_dpp v177, v173, v175 quad_perm:[2,3,0,1] row_mask:0xf bank_mask:0xf
    v_cndmask_b32 v172, v177, v176, s[56:57]
    v_cndmask_b32 v174, v176, v177, s[56:57]
    s_nop 1
    v_add_f32_dpp v228, v172, v174 quad_perm:[1,0,3,2] row_mask:0xf bank_mask:0xf
    buffer_store_dwordx2 v[228:229], v230, s[28:31], s73 offen sc1
    s_waitcnt lgkmcnt(0)
    v_pk_fma_f32 v[136:137], v[80:81], v[64:65], v[136:137] op_sel_hi:[0,1,1] neg_lo:[1,0,0] neg_hi:[1,0,0]
    v_pk_fma_f32 v[138:139], v[80:81], v[66:67], v[138:139] op_sel_hi:[0,1,1] neg_lo:[1,0,0] neg_hi:[1,0,0]
    v_pk_fma_f32 v[152:153], v[82:83], v[64:65], v[152:153] op_sel_hi:[0,1,1] neg_lo:[1,0,0] neg_hi:[1,0,0]
    v_pk_fma_f32 v[154:155], v[82:83], v[66:67], v[154:155] op_sel_hi:[0,1,1] neg_lo:[1,0,0] neg_hi:[1,0,0]
    v_pk_fma_f32 v[140:141], v[80:81], v[68:69], v[140:141] op_sel_hi:[0,1,1] neg_lo:[1,0,0] neg_hi:[1,0,0]
    v_pk_fma_f32 v[142:143], v[80:81], v[70:71], v[142:143] op_sel_hi:[0,1,1] neg_lo:[1,0,0] neg_hi:[1,0,0]
    v_pk_fma_f32 v[156:157], v[82:83], v[68:69], v[156:157] op_sel_hi:[0,1,1] neg_lo:[1,0,0] neg_hi:[1,0,0]
    v_pk_fma_f32 v[158:159], v[82:83], v[70:71], v[158:159] op_sel_hi:[0,1,1] neg_lo:[1,0,0] neg_hi:[1,0,0]
    v_pk_mul_f32 v[136:137], v[136:137], v[84:85] op_sel_hi:[1,0]
    v_pk_mul_f32 v[138:139], v[138:139], v[84:85] op_sel_hi:[1,0]
    v_pk_mul_f32 v[152:153], v[152:153], v[86:87] op_sel_hi:[1,0]
    v_pk_mul_f32 v[154:155], v[154:155], v[86:87] op_sel_hi:[1,0]
    v_pk_mul_f32 v[140:141], v[140:141], v[84:85] op_sel_hi:[1,0]
    v_pk_mul_f32 v[142:143], v[142:143], v[84:85] op_sel_hi:[1,0]
    v_pk_mul_f32 v[156:157], v[156:157], v[86:87] op_sel_hi:[1,0]
    v_pk_mul_f32 v[158:159], v[158:159], v[86:87] op_sel_hi:[1,0]
    v_pk_mul_f32 v[48:49], v[136:137], v[136:137]
    v_pk_mul_f32 v[50:51], v[138:139], v[138:139]
    v_pk_mul_f32 v[52:53], v[152:153], v[152:153]
    v_pk_mul_f32 v[54:55], v[154:155], v[154:155]
    v_pk_mul_f32 v[56:57], v[140:141], v[140:141]
    v_pk_mul_f32 v[58:59], v[142:143], v[142:143]
    v_pk_mul_f32 v[60:61], v[156:157], v[156:157]
    v_pk_mul_f32 v[62:63], v[158:159], v[158:159]
    v_pk_fma_f32 v[48:49], v[48:49], v[88:89], v[90:91] op_sel_hi:[1,0,0]
    v_pk_fma_f32 v[50:51], v[50:51], v[88:89], v[90:91] op_sel_hi:[1,0,0]
    v_pk_fma_f32 v[52:53], v[52:53], v[88:89], v[90:91] op_sel_hi:[1,0,0]
    v_pk_fma_f32 v[54:55], v[54:55], v[88:89], v[90:91] op_sel_hi:[1,0,0]
    v_pk_fma_f32 v[56:57], v[56:57], v[88:89], v[90:91] op_sel_hi:[1,0,0]
    v_pk_fma_f32 v[58:59], v[58:59], v[88:89], v[90:91] op_sel_hi:[1,0,0]
    v_pk_fma_f32 v[60:61], v[60:61], v[88:89], v[90:91] op_sel_hi:[1,0,0]
    v_pk_fma_f32 v[62:63], v[62:63], v[88:89], v[90:91] op_sel_hi:[1,0,0]
    v_pk_mul_f32 v[48:49], v[48:49], v[136:137]
    v_pk_mul_f32 v[50:51], v[50:51], v[138:139]
    v_pk_mul_f32 v[52:53], v[52:53], v[152:153]
    v_pk_mul_f32 v[54:55], v[54:55], v[154:155]
    v_pk_mul_f32 v[56:57], v[56:57], v[140:141]
    v_pk_mul_f32 v[58:59], v[58:59], v[142:143]
    v_pk_mul_f32 v[60:61], v[60:61], v[156:157]
    v_pk_mul_f32 v[62:63], v[62:63], v[158:159]
    v_exp_f32 v48, v48
    v_exp_f32 v49, v49
    v_exp_f32 v50, v50
    v_exp_f32 v51, v51
    v_exp_f32 v52, v52
    v_exp_f32 v53, v53
    v_exp_f32 v54, v54
    v_exp_f32 v55, v55
    v_exp_f32 v56, v56
    v_exp_f32 v57, v57
    v_exp_f32 v58, v58
    v_exp_f32 v59, v59
    v_exp_f32 v60, v60
    v_exp_f32 v61, v61
    v_exp_f32 v62, v62
    v_exp_f32 v63, v63
    v_pk_add_f32 v[48:49], v[48:49], 1.0 op_sel_hi:[1,0]
    v_pk_add_f32 v[50:51], v[50:51], 1.0 op_sel_hi:[1,0]
    v_pk_add_f32 v[52:53], v[52:53], 1.0 op_sel_hi:[1,0]
    v_pk_add_f32 v[54:55], v[54:55], 1.0 op_sel_hi:[1,0]
    v_pk_add_f32 v[56:57], v[56:57], 1.0 op_sel_hi:[1,0]
    v_pk_add_f32 v[58:59], v[58:59], 1.0 op_sel_hi:[1,0]
    v_pk_add_f32 v[60:61], v[60:61], 1.0 op_sel_hi:[1,0]
    v_pk_add_f32 v[62:63], v[62:63], 1.0 op_sel_hi:[1,0]
    v_rcp_f32 v48, v48
    v_rcp_f32 v49, v49
    v_rcp_f32 v50, v50
    v_rcp_f32 v51, v51
    v_rcp_f32 v52, v52
    v_rcp_f32 v53, v53
    v_rcp_f32 v54, v54
    v_rcp_f32 v55, v55
    v_rcp_f32 v56, v56
    v_rcp_f32 v57, v57
    v_rcp_f32 v58, v58
    v_rcp_f32 v59, v59
    v_rcp_f32 v60, v60
    v_rcp_f32 v61, v61
    v_rcp_f32 v62, v62
    v_rcp_f32 v63, v63
    v_pk_mul_f32 v[136:137], v[136:137], v[48:49]
    v_pk_mul_f32 v[138:139], v[138:139], v[50:51]
    v_pk_mul_f32 v[152:153], v[152:153], v[52:53]
    v_pk_mul_f32 v[154:155], v[154:155], v[54:55]
    v_pk_mul_f32 v[140:141], v[140:141], v[56:57]
    v_pk_mul_f32 v[142:143], v[142:143], v[58:59]
    v_pk_mul_f32 v[156:157], v[156:157], v[60:61]
    v_pk_mul_f32 v[158:159], v[158:159], v[62:63]
    v_cvt_pk_bf16_f32 v168, v136, v137
    v_cvt_pk_bf16_f32 v169, v138, v139
    v_cvt_pk_bf16_f32 v176, v152, v153
    v_cvt_pk_bf16_f32 v177, v154, v155
    v_cvt_pk_bf16_f32 v170, v140, v141
    v_cvt_pk_bf16_f32 v171, v142, v143
    v_cvt_pk_bf16_f32 v178, v156, v157
    v_cvt_pk_bf16_f32 v179, v158, v159
    buffer_load_dwordx4 v[200:203], v12, s[28:31], s72 offen offset:0 sc1
    buffer_load_dwordx4 v[204:207], v12, s[28:31], s72 offen offset:1024 sc1
    buffer_load_dwordx4 v[208:211], v12, s[28:31], s72 offen offset:2048 sc1
    buffer_load_dwordx4 v[212:215], v12, s[28:31], s72 offen offset:3072 sc1
    buffer_load_dwordx4 v[216:219], v13, s[28:31], s72 offen offset:0 sc1
    buffer_load_dwordx4 v[220:223], v13, s[28:31], s72 offen offset:1024 sc1
    buffer_load_dwordx4 v[224:227], v13, s[28:31], s72 offen offset:2048 sc1
    v_pk_fma_f32 v[144:145], v[80:81], v[72:73], v[144:145] op_sel_hi:[0,1,1] neg_lo:[1,0,0] neg_hi:[1,0,0]
    v_pk_fma_f32 v[146:147], v[80:81], v[74:75], v[146:147] op_sel_hi:[0,1,1] neg_lo:[1,0,0] neg_hi:[1,0,0]
    v_pk_fma_f32 v[160:161], v[82:83], v[72:73], v[160:161] op_sel_hi:[0,1,1] neg_lo:[1,0,0] neg_hi:[1,0,0]
    v_pk_fma_f32 v[162:163], v[82:83], v[74:75], v[162:163] op_sel_hi:[0,1,1] neg_lo:[1,0,0] neg_hi:[1,0,0]
    v_pk_fma_f32 v[148:149], v[80:81], v[76:77], v[148:149] op_sel_hi:[0,1,1] neg_lo:[1,0,0] neg_hi:[1,0,0]
    v_pk_fma_f32 v[150:151], v[80:81], v[78:79], v[150:151] op_sel_hi:[0,1,1] neg_lo:[1,0,0] neg_hi:[1,0,0]
    v_pk_fma_f32 v[164:165], v[82:83], v[76:77], v[164:165] op_sel_hi:[0,1,1] neg_lo:[1,0,0] neg_hi:[1,0,0]
    v_pk_fma_f32 v[166:167], v[82:83], v[78:79], v[166:167] op_sel_hi:[0,1,1] neg_lo:[1,0,0] neg_hi:[1,0,0]
    v_pk_mul_f32 v[144:145], v[144:145], v[84:85] op_sel_hi:[1,0]
    v_pk_mul_f32 v[146:147], v[146:147], v[84:85] op_sel_hi:[1,0]
    v_pk_mul_f32 v[160:161], v[160:161], v[86:87] op_sel_hi:[1,0]
    v_pk_mul_f32 v[162:163], v[162:163], v[86:87] op_sel_hi:[1,0]
    v_pk_mul_f32 v[148:149], v[148:149], v[84:85] op_sel_hi:[1,0]
    v_pk_mul_f32 v[150:151], v[150:151], v[84:85] op_sel_hi:[1,0]
    v_pk_mul_f32 v[164:165], v[164:165], v[86:87] op_sel_hi:[1,0]
    v_pk_mul_f32 v[166:167], v[166:167], v[86:87] op_sel_hi:[1,0]
    v_pk_mul_f32 v[48:49], v[144:145], v[144:145]
    v_pk_mul_f32 v[50:51], v[146:147], v[146:147]
    v_pk_mul_f32 v[52:53], v[160:161], v[160:161]
    v_pk_mul_f32 v[54:55], v[162:163], v[162:163]
    v_pk_mul_f32 v[56:57], v[148:149], v[148:149]
    v_pk_mul_f32 v[58:59], v[150:151], v[150:151]
    v_pk_mul_f32 v[60:61], v[164:165], v[164:165]
    v_pk_mul_f32 v[62:63], v[166:167], v[166:167]
    v_pk_fma_f32 v[48:49], v[48:49], v[88:89], v[90:91] op_sel_hi:[1,0,0]
    v_pk_fma_f32 v[50:51], v[50:51], v[88:89], v[90:91] op_sel_hi:[1,0,0]
    v_pk_fma_f32 v[52:53], v[52:53], v[88:89], v[90:91] op_sel_hi:[1,0,0]
    v_pk_fma_f32 v[54:55], v[54:55], v[88:89], v[90:91] op_sel_hi:[1,0,0]
    v_pk_fma_f32 v[56:57], v[56:57], v[88:89], v[90:91] op_sel_hi:[1,0,0]
    v_pk_fma_f32 v[58:59], v[58:59], v[88:89], v[90:91] op_sel_hi:[1,0,0]
    v_pk_fma_f32 v[60:61], v[60:61], v[88:89], v[90:91] op_sel_hi:[1,0,0]
    v_pk_fma_f32 v[62:63], v[62:63], v[88:89], v[90:91] op_sel_hi:[1,0,0]
    v_pk_mul_f32 v[48:49], v[48:49], v[144:145]
    v_pk_mul_f32 v[50:51], v[50:51], v[146:147]
    v_pk_mul_f32 v[52:53], v[52:53], v[160:161]
    v_pk_mul_f32 v[54:55], v[54:55], v[162:163]
    v_pk_mul_f32 v[56:57], v[56:57], v[148:149]
    v_pk_mul_f32 v[58:59], v[58:59], v[150:151]
    v_pk_mul_f32 v[60:61], v[60:61], v[164:165]
    v_pk_mul_f32 v[62:63], v[62:63], v[166:167]
    v_exp_f32 v48, v48
    v_exp_f32 v49, v49
    v_exp_f32 v50, v50
    v_exp_f32 v51, v51
    v_exp_f32 v52, v52
    v_exp_f32 v53, v53
    v_exp_f32 v54, v54
    v_exp_f32 v55, v55
    v_exp_f32 v56, v56
    v_exp_f32 v57, v57
    v_exp_f32 v58, v58
    v_exp_f32 v59, v59
    v_exp_f32 v60, v60
    v_exp_f32 v61, v61
    v_exp_f32 v62, v62
    v_exp_f32 v63, v63
    v_pk_add_f32 v[48:49], v[48:49], 1.0 op_sel_hi:[1,0]
    v_pk_add_f32 v[50:51], v[50:51], 1.0 op_sel_hi:[1,0]
    v_pk_add_f32 v[52:53], v[52:53], 1.0 op_sel_hi:[1,0]
    v_pk_add_f32 v[54:55], v[54:55], 1.0 op_sel_hi:[1,0]
    v_pk_add_f32 v[56:57], v[56:57], 1.0 op_sel_hi:[1,0]
    v_pk_add_f32 v[58:59], v[58:59], 1.0 op_sel_hi:[1,0]
    v_pk_add_f32 v[60:61], v[60:61], 1.0 op_sel_hi:[1,0]
    v_pk_add_f32 v[62:63], v[62:63], 1.0 op_sel_hi:[1,0]
    v_rcp_f32 v48, v48
    v_rcp_f32 v49, v49
    v_rcp_f32 v50, v50
    v_rcp_f32 v51, v51
    v_rcp_f32 v52, v52
    v_rcp_f32 v53, v53
    v_rcp_f32 v54, v54
    v_rcp_f32 v55, v55
    v_rcp_f32 v56, v56
    v_rcp_f32 v57, v57
    v_rcp_f32 v58, v58
    v_rcp_f32 v59, v59
    v_rcp_f32 v60, v60
    v_rcp_f32 v61, v61
    v_rcp_f32 v62, v62
    v_rcp_f32 v63, v63
    v_pk_mul_f32 v[144:145], v[144:145], v[48:49]
    v_pk_mul_f32 v[146:147], v[146:147], v[50:51]
    v_pk_mul_f32 v[160:161], v[160:161], v[52:53]
    v_pk_mul_f32 v[162:163], v[162:163], v[54:55]
    v_pk_mul_f32 v[148:149], v[148:149], v[56:57]
    v_pk_mul_f32 v[150:151], v[150:151], v[58:59]
    v_pk_mul_f32 v[164:165], v[164:165], v[60:61]
    v_pk_mul_f32 v[166:167], v[166:167], v[62:63]
    v_cvt_pk_bf16_f32 v172, v144, v145
    v_cvt_pk_bf16_f32 v173, v146, v147
    v_cvt_pk_bf16_f32 v180, v160, v161
    v_cvt_pk_bf16_f32 v181, v162, v163
    v_cvt_pk_bf16_f32 v174, v148, v149
    v_cvt_pk_bf16_f32 v175, v150, v151
    v_cvt_pk_bf16_f32 v182, v164, v165
    v_cvt_pk_bf16_f32 v183, v166, v167
    s_bitcmp1_b32 s33, 0
    s_cbranch_scc0 m_noswap
    v_swap_b32 v168, v170
    v_swap_b32 v169, v171
    v_swap_b32 v172, v174
    v_swap_b32 v173, v175
    v_swap_b32 v176, v178
    v_swap_b32 v177, v179
    v_swap_b32 v180, v182
    v_swap_b32 v181, v183
m_noswap:
    s_setprio 2
    s_mov_b32 s40, 0
    s_waitcnt vmcnt(0)
    v_xor_b32 v4, v201, v229
    v_xor_b32 v5, v203, v229
    v_xor_b32 v9, v205, v229
    v_xor_b32 v10, v207, v229
    v_or3_b32 v4, v4, v9, v10
    v_xor_b32 v9, v209, v229
    v_xor_b32 v10, v211, v229
    v_or3_b32 v4, v4, v9, v10
    v_xor_b32 v9, v213, v229
    v_xor_b32 v10, v215, v229
    v_or3_b32 v4, v4, v9, v10
    v_xor_b32 v9, v217, v229
    v_xor_b32 v10, v219, v229
    v_or3_b32 v4, v4, v9, v10
    v_xor_b32 v9, v221, v229
    v_xor_b32 v10, v223, v229
    v_or3_b32 v4, v4, v9, v10
    v_xor_b32 v9, v225, v229
    v_xor_b32 v10, v227, v229
    v_or3_b32 v4, v4, v9, v10
    v_or_b32 v4, v4, v5
    v_cmp_ne_u32 vcc, 0, v4
    s_nop 1
    s_cbranch_vccnz m_repoll
    buffer_store_dwordx4 v[168:171], v12, s[20:23], s68 offen sc1
    buffer_store_dwordx4 v[172:175], v12, s[20:23], s69 offen sc1
    buffer_store_dwordx4 v[176:179], v12, s[20:23], s70 offen sc1
    buffer_store_dwordx4 v[180:183], v12, s[20:23], s71 offen sc1
    s_branch m_poll_done
m_repoll:
    buffer_load_dwordx4 v[200:203], v12, s[28:31], s72 offen offset:0 sc1
    buffer_load_dwordx4 v[204:207], v12, s[28:31], s72 offen offset:1024 sc1
    buffer_load_dwordx4 v[208:211], v12, s[28:31], s72 offen offset:2048 sc1
    buffer_load_dwordx4 v[212:215], v12, s[28:31], s72 offen offset:3072 sc1
    buffer_load_dwordx4 v[216:219], v13, s[28:31], s72 offen offset:0 sc1
    buffer_load_dwordx4 v[220:223], v13, s[28:31], s72 offen offset:1024 sc1
    buffer_load_dwordx4 v[224:227], v13, s[28:31], s72 offen offset:2048 sc1
    buffer_store_dwordx4 v[168:171], v12, s[20:23], s68 offen sc1
    buffer_store_dwordx4 v[172:175], v12, s[20:23], s69 offen sc1
    buffer_store_dwordx4 v[176:179], v12, s[20:23], s70 offen sc1
    buffer_store_dwordx4 v[180:183], v12, s[20:23], s71 offen sc1
    s_waitcnt vmcnt(4)
    s_branch m_check
m_poll:
    buffer_load_dwordx4 v[200:203], v12, s[28:31], s72 offen offset:0 sc1
    buffer_load_dwordx4 v[204:207], v12, s[28:31], s72 offen offset:1024 sc1
    buffer_load_dwordx4 v[208:211], v12, s[28:31], s72 offen offset:2048 sc1
    buffer_load_dwordx4 v[212:215], v12, s[28:31], s72 offen offset:3072 sc1
    buffer_load_dwordx4 v[216:219], v13, s[28:31], s72 offen offset:0 sc1
    buffer_load_dwordx4 v[220:223], v13, s[28:31], s72 offen offset:1024 sc1
    buffer_load_dwordx4 v[224:227], v13, s[28:31], s72 offen offset:2048 sc1
    s_waitcnt vmcnt(0)
m_check:
    v_xor_b32 v4, v201, v229
    v_xor_b32 v5, v203, v229
    v_xor_b32 v9, v205, v229
    v_xor_b32 v10, v207, v229
    v_or3_b32 v4, v4, v9, v10
    v_xor_b32 v9, v209, v229
    v_xor_b32 v10, v211, v229
    v_or3_b32 v4, v4, v9, v10
    v_xor_b32 v9, v213, v229
    v_xor_b32 v10, v215, v229
    v_or3_b32 v4, v4, v9, v10
    v_xor_b32 v9, v217, v229
    v_xor_b32 v10, v219, v229
    v_or3_b32 v4, v4, v9, v10
    v_xor_b32 v9, v221, v229
    v_xor_b32 v10, v223, v229
    v_or3_b32 v4, v4, v9, v10
    v_xor_b32 v9, v225, v229
    v_xor_b32 v10, v227, v229
    v_or3_b32 v4, v4, v9, v10
    v_or_b32 v4, v4, v5
    v_cmp_ne_u32 vcc, 0, v4
    s_add_u32 s40, s40, 1
    s_nop 0
    s_cbranch_vccz m_poll_done
    s_cmp_lt_u32 s40, 262144
    s_cbranch_scc1 m_poll
m_poll_done:
    v_add_f32 v200, v200, v204
    v_add_f32 v202, v202, v206
    v_add_f32 v200, v200, v208
    v_add_f32 v202, v202, v210
    v_add_f32 v200, v200, v212
    v_add_f32 v202, v202, v214
    v_add_f32 v200, v200, v216
    v_add_f32 v202, v202, v218
    v_add_f32 v200, v200, v220
    v_add_f32 v202, v202, v222
    v_add_f32 v200, v200, v224
    v_add_f32 v202, v202, v226
    v_mov_b32 v201, v200
    v_mov_b32 v203, v202
    s_nop 1
    v_permlane32_swap_b32 v200, v201
    v_permlane32_swap_b32 v202, v203
    s_nop 1
    v_add_f32 v24, v200, v201
    v_add_f32 v26, v202, v203
    v_mul_f32 v24, 0x3a97b426, v24
    v_mul_f32 v26, 0x3a97b426, v26
    v_fma_f32 v26, -v24, v24, v26
    v_max_f32 v26, 0, v26
    v_cvt_pk_bf16_f32 v25, v24, v26
    v_lshlrev_b32 v24, 16, v25
    v_and_b32 v26, 0xffff0000, v25
    v_add_f32 v26, 0x3727c5ac, v26
    v_cvt_pk_bf16_f32 v25, v26, v26
    v_and_b32 v26, 0xffff0000, v25
    v_sqrt_f32 v26, v26
    s_nop 0
    v_cvt_pk_bf16_f32 v25, v26, v26
    v_and_b32 v26, 0xffff0000, v25
    v_rcp_f32 v26, v26
    s_nop 0
    s_lshl_b32 s43, s33, 8
    s_add_u32 s43, s43, 162688
    v_and_b32 v4, 31, v1
    v_lshl_add_u32 v4, v4, 2, s43
    v_lshl_add_u32 v5, v3, 5, s43
    v_mul_f32 v24, v24, v26
    ds_write_b32 v4, v24
    ds_write_b32 v4, v26 offset:128
    ds_read_b128 v[28:31], v5
    ds_read_b128 v[32:35], v5 offset:16
    ds_read_b128 v[36:39], v5 offset:128
    ds_read_b128 v[40:43], v5 offset:144
    s_waitcnt lgkmcnt(0)
    v_pk_fma_f32 v[104:105], v[104:105], v[36:37], v[28:29] neg_lo:[0,0,1] neg_hi:[0,0,1]
    v_pk_fma_f32 v[106:107], v[106:107], v[38:39], v[30:31] neg_lo:[0,0,1] neg_hi:[0,0,1]
    v_pk_fma_f32 v[120:121], v[120:121], v[40:41], v[32:33] neg_lo:[0,0,1] neg_hi:[0,0,1]
    v_pk_fma_f32 v[122:123], v[122:123], v[42:43], v[34:35] neg_lo:[0,0,1] neg_hi:[0,0,1]
    v_pk_fma_f32 v[108:109], v[108:109], v[36:37], v[28:29] neg_lo:[0,0,1] neg_hi:[0,0,1]
    v_pk_fma_f32 v[110:111], v[110:111], v[38:39], v[30:31] neg_lo:[0,0,1] neg_hi:[0,0,1]
    v_pk_fma_f32 v[124:125], v[124:125], v[40:41], v[32:33] neg_lo:[0,0,1] neg_hi:[0,0,1]
    v_pk_fma_f32 v[126:127], v[126:127], v[42:43], v[34:35] neg_lo:[0,0,1] neg_hi:[0,0,1]
    v_cvt_pk_bf16_f32 v64, v104, v105
    v_cvt_pk_bf16_f32 v65, v106, v107
    v_cvt_pk_bf16_f32 v66, v120, v121
    v_cvt_pk_bf16_f32 v67, v122, v123
    v_cvt_pk_bf16_f32 v68, v108, v109
    v_cvt_pk_bf16_f32 v69, v110, v111
    v_cvt_pk_bf16_f32 v70, v124, v125
    v_cvt_pk_bf16_f32 v71, v126, v127
    buffer_store_dwordx4 v[64:67], v12, s[24:27], s46 offen sc1
    buffer_store_dwordx4 v[68:71], v12, s[24:27], s47 offen sc1
    v_pk_fma_f32 v[112:113], v[112:113], v[36:37], v[28:29] neg_lo:[0,0,1] neg_hi:[0,0,1]
    v_pk_fma_f32 v[114:115], v[114:115], v[38:39], v[30:31] neg_lo:[0,0,1] neg_hi:[0,0,1]
    v_pk_fma_f32 v[128:129], v[128:129], v[40:41], v[32:33] neg_lo:[0,0,1] neg_hi:[0,0,1]
    v_pk_fma_f32 v[130:131], v[130:131], v[42:43], v[34:35] neg_lo:[0,0,1] neg_hi:[0,0,1]
    v_pk_fma_f32 v[116:117], v[116:117], v[36:37], v[28:29] neg_lo:[0,0,1] neg_hi:[0,0,1]
    v_pk_fma_f32 v[118:119], v[118:119], v[38:39], v[30:31] neg_lo:[0,0,1] neg_hi:[0,0,1]
    v_pk_fma_f32 v[132:133], v[132:133], v[40:41], v[32:33] neg_lo:[0,0,1] neg_hi:[0,0,1]
    v_pk_fma_f32 v[134:135], v[134:135], v[42:43], v[34:35] neg_lo:[0,0,1] neg_hi:[0,0,1]
    v_cvt_pk_bf16_f32 v72, v112, v113
    v_cvt_pk_bf16_f32 v73, v114, v115
    v_cvt_pk_bf16_f32 v74, v128, v129
    v_cvt_pk_bf16_f32 v75, v130, v131
    v_cvt_pk_bf16_f32 v76, v116, v117
    v_cvt_pk_bf16_f32 v77, v118, v119
    v_cvt_pk_bf16_f32 v78, v132, v133
    v_cvt_pk_bf16_f32 v79, v134, v135
    buffer_store_dwordx4 v[72:75], v12, s[24:27], s48 offen sc1
    buffer_store_dwordx4 v[76:79], v12, s[24:27], s49 offen sc1
    s_lshl_b32 s43, s36, 2
    s_mov_b32 s44, 0x33221000
    s_mov_b32 s45, 0x00766554
    s_lshr_b64 s[44:45], s[44:45], s43
    s_and_b32 s46, s44, 15
    s_mov_b32 s44, 0x44322110
    s_mov_b32 s45, 0x00776655
    s_lshr_b64 s[44:45], s[44:45], s43
    s_and_b32 s47, s44, 15
    s_lshl_b32 s43, s46, 2
    s_lshr_b32 s44, 0xca865310, s43
    s_and_b32 s44, s44, 15
    s_sub_u32 s44, s36, s44
    s_lshl_b32 s44, s44, 4
    s_add_u32 s44, s44, s35
    s_lshl_b32 s44, s44, 2
    s_lshl_b32 s46, s46, 8
    s_add_u32 s46, s46, s44
    s_lshl_b32 s43, s47, 2
    s_lshr_b32 s44, 0xca865310, s43
    s_and_b32 s44, s44, 15
    s_sub_u32 s44, s36, s44
    s_lshl_b32 s44, s44, 4
    s_add_u32 s44, s44, s35
    s_lshl_b32 s44, s44, 2
    s_lshl_b32 s47, s47, 8
    s_add_u32 s47, s47, s44
    v_mov_b32 v6, s46
    v_mov_b32 v7, s47
    v_cmp_lt_u32 vcc, 31, v1
    v_and_b32 v8, 31, v1
    v_lshlrev_b32 v8, 11, v8
    v_cndmask_b32 v6, v6, v7, vcc
    v_add_u32 v6, v6, v8
    v_mov_b32 v4, 163724
    v_mov_b32 v5, 1
    v_mov_b32 v7, s3
    s_mov_b32 s44, 65536
    s_mov_b64 exec, 1
    s_waitcnt vmcnt(0)
    ds_add_rtn_u32 v8, v4, v5
    s_waitcnt lgkmcnt(0)
    v_readfirstlane_b32 s43, v8
    s_mov_b64 exec, -1
    s_cmp_lg_u32 s43, 3
    s_cbranch_scc1 m_P2
    buffer_store_dword v7, v6, s[60:63], s44 offen sc1
m_P2:
    s_load_dwordx2 s[6:7], s[0:1], 80
    s_lshr_b32 s35, s41, 1
    s_lshl_b32 s35, s35, 3
    s_lshr_b32 s43, s42, 2
    s_add_u32 s35, s35, s43
    s_and_b32 s36, s42, 3
    s_and_b32 s43, s41, 1
    s_mul_i32 s43, s43, 27
    s_mul_i32 s44, s36, 7
    s_add_u32 s37, s43, s44
    v_and_b32 v240, 15, v1
    v_lshrrev_b32 v241, 4, v1
    v_mov_b32 v245, v1
    v_lshrrev_b32 v2, 5, v1
    v_lshlrev_b32 v2, 3, v2
    v_bfe_u32 v3, v1, 3, 2
    v_add_u32 v2, v2, v3
    v_lshlrev_b32 v2, 12, v2
    v_and_b32 v3, 7, v1
    v_xor_b32 v3, v3, v241
    v_lshl_add_u32 v242, v3, 4, v2
    v_xor_b32 v3, 4, v3
    v_lshl_add_u32 v243, v3, 4, v2
    v_add_u32 v243, 64512, v243
    v_lshlrev_b32 v244, 4, v1
    s_lshl_b32 s43, s35, 18
    s_lshl_b32 s44, s33, 10
    s_add_u32 s48, s43, s44
    s_add_u32 s49, s48, 16384
    s_add_u32 s50, s48, 131072
    s_add_u32 s51, s48, 147456
    s_lshl_b32 s43, s37, 16
    s_lshl_b32 s44, s33, 14
    s_add_u32 s52, s43, s44
    s_add_u32 s53, s52, 65536
    s_add_u32 s54, s52, 131072
    s_add_u32 s55, s52, 196608
    s_add_u32 s56, s52, 262144
    s_add_u32 s57, s52, 327680
    s_add_u32 s58, s52, 393216
    s_cmp_eq_u32 s36, 3
    s_cselect_b32 s58, 1073741824, s58
    s_mul_i32 s39, s33, 16384
    s_mov_b32 s16, s10
    s_mov_b32 s17, s11
    s_mov_b32 s18, 8388608
    s_mov_b32 s19, 0x00020000
    s_add_u32 s20, s14, 4194304
    s_addc_u32 s21, s15, 0
    s_mov_b32 s22, 3538944
    s_mov_b32 s23, 0x00020000
    s_add_u32 s24, s14, 8388608
    s_addc_u32 s25, s15, 0
    s_mov_b32 s26, 3538944
    s_mov_b32 s27, 0x00020000
    s_add_u32 s28, s14, 12582912
    s_addc_u32 s29, s15, 0
    s_mov_b32 s30, 3538944
    s_mov_b32 s31, 0x00020000
    v_lshrrev_b32 v5, 1, v240
    v_xor_b32 v5, v5, v241
    v_lshlrev_b32 v4, 7, v240
    v_lshl_add_u32 v4, v5, 4, v4
    v_add_u32 v4, s39, v4
    s_xor_b32 s43, s33, 0
    s_lshl_b32 s43, s43, 11
    v_add_u32 v246, s43, v4
    v_xor_b32 v250, 64, v246
    s_xor_b32 s43, s33, 1
    s_lshl_b32 s43, s43, 11
    v_add_u32 v247, s43, v4
    v_xor_b32 v251, 64, v247
    s_xor_b32 s43, s33, 2
    s_lshl_b32 s43, s43, 11
    v_add_u32 v248, s43, v4
    v_xor_b32 v252, 64, v248
    s_xor_b32 s43, s33, 3
    s_lshl_b32 s43, s43, 11
    v_add_u32 v249, s43, v4
    v_xor_b32 v253, 64, v249
    s_setprio 0
    s_lshl_b32 s38, s33, 13
    s_add_u32 s38, s38, 111616
    s_sub_u32 s59, s38, s39
    s_add_u32 s48, s48, 384
    s_add_u32 s49, s49, 384
    s_add_u32 s50, s50, 384
    s_add_u32 s51, s51, 384
    v_mov_b32 v4, 163788
    s_mov_b32 s40, 0
m_wpf0:
    s_sleep 1
    ds_read_b32 v5, v4
    s_add_u32 s40, s40, 1
    s_waitcnt lgkmcnt(0)
    v_readfirstlane_b32 s43, v5
    s_cmp_ge_u32 s40, 2097152
    s_cbranch_scc1 m_wpf0_ok
    s_cmp_eq_u32 s43, 0
    s_cbranch_scc1 m_wpf0
m_wpf0_ok:
    ds_read_b128 v[224:227], v246
    ds_read_b128 v[228:231], v247
    ds_read_b128 v[232:235], v248
    ds_read_b128 v[236:239], v249
    ds_read_b128 v[196:199], v250
    ds_read_b128 v[200:203], v251
    ds_read_b128 v[204:207], v252
    ds_read_b128 v[208:211], v253
    s_waitcnt lgkmcnt(0)
    s_add_u32 m0, s39, 0
    s_nop 0
    buffer_load_dwordx4 v242, s[16:19], s48 offen lds
    buffer_load_dwordx4 v243, s[16:19], s48 offen offset:1024 lds
    s_add_u32 s48, s48, 128
    s_add_u32 m0, s39, 2048
    s_nop 0
    buffer_load_dwordx4 v242, s[16:19], s49 offen lds
    buffer_load_dwordx4 v243, s[16:19], s49 offen offset:1024 lds
    s_add_u32 s49, s49, 128
    s_add_u32 m0, s39, 4096
    s_nop 0
    buffer_load_dwordx4 v242, s[16:19], s50 offen lds
    buffer_load_dwordx4 v243, s[16:19], s50 offen offset:1024 lds
    s_add_u32 s50, s50, 128
    s_add_u32 m0, s39, 6144
    s_nop 0
    buffer_load_dwordx4 v242, s[16:19], s51 offen lds
    buffer_load_dwordx4 v243, s[16:19], s51 offen offset:1024 lds
    s_add_u32 s51, s51, 128
    v_mov_b32 v4, 163716
    s_mov_b32 s40, 0
m_wpf:
    s_sleep 1
    ds_read_b32 v5, v4
    s_add_u32 s40, s40, 1
    s_waitcnt lgkmcnt(0)
    v_readfirstlane_b32 s43, v5
    s_cmp_ge_u32 s40, 2097152
    s_cbranch_scc1 m_wpf_ok
    s_cmp_eq_u32 s43, 0
    s_cbranch_scc1 m_wpf
m_wpf_ok:
    s_mov_b32 s64, s6
    s_mov_b32 s65, s7
    s_mov_b32 s66, 4096
    s_mov_b32 s67, 0x00020000
    s_setprio 3
    buffer_load_dwordx4 v[112:115], v244, s[20:23], s52 offen offset:0 sc1
    buffer_load_dwordx4 v[116:119], v244, s[20:23], s53 offen offset:0 sc1
    buffer_load_dwordx4 v[120:123], v244, s[20:23], s54 offen offset:0 sc1
    buffer_load_dwordx4 v[124:127], v244, s[20:23], s55 offen offset:0 sc1
    buffer_load_dwordx4 v[128:131], v244, s[20:23], s56 offen offset:0 sc1
    buffer_load_dwordx4 v[132:135], v244, s[20:23], s57 offen offset:0 sc1
    buffer_load_dwordx4 v[136:139], v244, s[20:23], s58 offen offset:0 sc1
    buffer_load_dwordx4 v[140:143], v244, s[20:23], s52 offen offset:1024 sc1
    buffer_load_dwordx4 v[144:147], v244, s[20:23], s53 offen offset:1024 sc1
    buffer_load_dwordx4 v[148:151], v244, s[20:23], s54 offen offset:1024 sc1
    buffer_load_dwordx4 v[152:155], v244, s[20:23], s55 offen offset:1024 sc1
    buffer_load_dwordx4 v[156:159], v244, s[20:23], s56 offen offset:1024 sc1
    buffer_load_dwordx4 v[160:163], v244, s[20:23], s57 offen offset:1024 sc1
    buffer_load_dwordx4 v[164:167], v244, s[20:23], s58 offen offset:1024 sc1
    buffer_load_dwordx4 v[168:171], v244, s[20:23], s52 offen offset:2048 sc1
    buffer_load_dwordx4 v[172:175], v244, s[20:23], s53 offen offset:2048 sc1
    buffer_load_dwordx4 v[176:179], v244, s[20:23], s54 offen offset:2048 sc1
    buffer_load_dwordx4 v[180:183], v244, s[20:23], s55 offen offset:2048 sc1
    buffer_load_dwordx4 v[184:187], v244, s[20:23], s56 offen offset:2048 sc1
    buffer_load_dwordx4 v[188:191], v244, s[20:23], s57 offen offset:2048 sc1
    buffer_load_dwordx4 v[192:195], v244, s[20:23], s58 offen offset:2048 sc1
    s_waitcnt vmcnt(20)
    v_mfma_f32_16x16x32_bf16 v[0:3], v[112:115], v[224:227], 0
    v_mfma_f32_16x16x32_bf16 v[4:7], v[112:115], v[228:231], 0
    v_mfma_f32_16x16x32_bf16 v[8:11], v[112:115], v[232:235], 0
    v_mfma_f32_16x16x32_bf16 v[12:15], v[112:115], v[236:239], 0
    s_add_u32 s52, s52, 4096
    buffer_load_dwordx4 v[112:115], v244, s[20:23], s52 offen offset:0 sc1
    s_waitcnt vmcnt(20)
    v_mfma_f32_16x16x32_bf16 v[16:19], v[116:119], v[224:227], 0
    v_mfma_f32_16x16x32_bf16 v[20:23], v[116:119], v[228:231], 0
    v_mfma_f32_16x16x32_bf16 v[24:27], v[116:119], v[232:235], 0
    v_mfma_f32_16x16x32_bf16 v[28:31], v[116:119], v[236:239], 0
    s_add_u32 s53, s53, 4096
    buffer_load_dwordx4 v[116:119], v244, s[20:23], s53 offen offset:0 sc1
    s_waitcnt vmcnt(20)
    v_mfma_f32_16x16x32_bf16 v[32:35], v[120:123], v[224:227], 0
    v_mfma_f32_16x16x32_bf16 v[36:39], v[120:123], v[228:231], 0
    v_mfma_f32_16x16x32_bf16 v[40:43], v[120:123], v[232:235], 0
    v_mfma_f32_16x16x32_bf16 v[44:47], v[120:123], v[236:239], 0
    s_add_u32 s54, s54, 4096
    buffer_load_dwordx4 v[120:123], v244, s[20:23], s54 offen offset:0 sc1
    s_waitcnt vmcnt(20)
    v_mfma_f32_16x16x32_bf16 v[48:51], v[124:127], v[224:227], 0
    v_mfma_f32_16x16x32_bf16 v[52:55], v[124:127], v[228:231], 0
    v_mfma_f32_16x16x32_bf16 v[56:59], v[124:127], v[232:235], 0
    v_mfma_f32_16x16x32_bf16 v[60:63], v[124:127], v[236:239], 0
    s_add_u32 s55, s55, 4096
    buffer_load_dwordx4 v[124:127], v244, s[20:23], s55 offen offset:0 sc1
    s_waitcnt vmcnt(20)
    v_mfma_f32_16x16x32_bf16 v[64:67], v[128:131], v[224:227], 0
    v_mfma_f32_16x16x32_bf16 v[68:71], v[128:131], v[228:231], 0
    v_mfma_f32_16x16x32_bf16 v[72:75], v[128:131], v[232:235], 0
    v_mfma_f32_16x16x32_bf16 v[76:79], v[128:131], v[236:239], 0
    s_add_u32 s56, s56, 4096
    buffer_load_dwordx4 v[128:131], v244, s[20:23], s56 offen offset:0 sc1
    s_waitcnt vmcnt(20)
    v_mfma_f32_16x16x32_bf16 v[80:83], v[132:135], v[224:227], 0
    v_mfma_f32_16x16x32_bf16 v[84:87], v[132:135], v[228:231], 0
    v_mfma_f32_16x16x32_bf16 v[88:91], v[132:135], v[232:235], 0
    v_mfma_f32_16x16x32_bf16 v[92:95], v[132:135], v[236:239], 0
    s_add_u32 s57, s57, 4096
    buffer_load_dwordx4 v[132:135], v244, s[20:23], s57 offen offset:0 sc1
    s_waitcnt vmcnt(20)
    v_mfma_f32_16x16x32_bf16 v[96:99], v[136:139], v[224:227], 0
    v_mfma_f32_16x16x32_bf16 v[100:103], v[136:139], v[228:231], 0
    v_mfma_f32_16x16x32_bf16 v[104:107], v[136:139], v[232:235], 0
    v_mfma_f32_16x16x32_bf16 v[108:111], v[136:139], v[236:239], 0
    s_add_u32 s58, s58, 4096
    buffer_load_dwordx4 v[136:139], v244, s[20:23], s58 offen offset:0 sc1
    s_waitcnt vmcnt(20)
    v_mfma_f32_16x16x32_bf16 v[0:3], v[140:143], v[196:199], v[0:3]
    v_mfma_f32_16x16x32_bf16 v[4:7], v[140:143], v[200:203], v[4:7]
    v_mfma_f32_16x16x32_bf16 v[8:11], v[140:143], v[204:207], v[8:11]
    v_mfma_f32_16x16x32_bf16 v[12:15], v[140:143], v[208:211], v[12:15]
    s_waitcnt vmcnt(19)
    v_mfma_f32_16x16x32_bf16 v[16:19], v[144:147], v[196:199], v[16:19]
    v_mfma_f32_16x16x32_bf16 v[20:23], v[144:147], v[200:203], v[20:23]
    v_mfma_f32_16x16x32_bf16 v[24:27], v[144:147], v[204:207], v[24:27]
    v_mfma_f32_16x16x32_bf16 v[28:31], v[144:147], v[208:211], v[28:31]
    s_waitcnt vmcnt(18)
    v_mfma_f32_16x16x32_bf16 v[32:35], v[148:151], v[196:199], v[32:35]
    v_mfma_f32_16x16x32_bf16 v[36:39], v[148:151], v[200:203], v[36:39]
    v_mfma_f32_16x16x32_bf16 v[40:43], v[148:151], v[204:207], v[40:43]
    v_mfma_f32_16x16x32_bf16 v[44:47], v[148:151], v[208:211], v[44:47]
    s_waitcnt vmcnt(17)
    v_mfma_f32_16x16x32_bf16 v[48:51], v[152:155], v[196:199], v[48:51]
    v_mfma_f32_16x16x32_bf16 v[52:55], v[152:155], v[200:203], v[52:55]
    v_mfma_f32_16x16x32_bf16 v[56:59], v[152:155], v[204:207], v[56:59]
    v_mfma_f32_16x16x32_bf16 v[60:63], v[152:155], v[208:211], v[60:63]
    s_waitcnt vmcnt(16)
    v_mfma_f32_16x16x32_bf16 v[64:67], v[156:159], v[196:199], v[64:67]
    v_mfma_f32_16x16x32_bf16 v[68:71], v[156:159], v[200:203], v[68:71]
    v_mfma_f32_16x16x32_bf16 v[72:75], v[156:159], v[204:207], v[72:75]
    v_mfma_f32_16x16x32_bf16 v[76:79], v[156:159], v[208:211], v[76:79]
    s_waitcnt vmcnt(15)
    v_mfma_f32_16x16x32_bf16 v[80:83], v[160:163], v[196:199], v[80:83]
    v_mfma_f32_16x16x32_bf16 v[84:87], v[160:163], v[200:203], v[84:87]
    v_mfma_f32_16x16x32_bf16 v[88:91], v[160:163], v[204:207], v[88:91]
    v_mfma_f32_16x16x32_bf16 v[92:95], v[160:163], v[208:211], v[92:95]
    s_waitcnt vmcnt(14)
    v_mfma_f32_16x16x32_bf16 v[96:99], v[164:167], v[196:199], v[96:99]
    v_mfma_f32_16x16x32_bf16 v[100:103], v[164:167], v[200:203], v[100:103]
    v_mfma_f32_16x16x32_bf16 v[104:107], v[164:167], v[204:207], v[104:107]
    v_mfma_f32_16x16x32_bf16 v[108:111], v[164:167], v[208:211], v[108:111]
    s_sub_u32 s47, s52, 4096
    buffer_load_dwordx4 v[196:199], v244, s[20:23], s47 offen offset:3072 sc1
    s_sub_u32 s47, s53, 4096
    buffer_load_dwordx4 v[200:203], v244, s[20:23], s47 offen offset:3072 sc1
    s_sub_u32 s47, s54, 4096
    buffer_load_dwordx4 v[204:207], v244, s[20:23], s47 offen offset:3072 sc1
    s_sub_u32 s47, s55, 4096
    buffer_load_dwordx4 v[208:211], v244, s[20:23], s47 offen offset:3072 sc1
    s_sub_u32 s47, s56, 4096
    buffer_load_dwordx4 v[212:215], v244, s[20:23], s47 offen offset:3072 sc1
    s_sub_u32 s47, s57, 4096
    buffer_load_dwordx4 v[216:219], v244, s[20:23], s47 offen offset:3072 sc1
    s_sub_u32 s47, s58, 4096
    buffer_load_dwordx4 v[220:223], v244, s[20:23], s47 offen offset:3072 sc1
    buffer_load_dwordx4 v[140:143], v244, s[20:23], s52 offen offset:1024 sc1
    buffer_load_dwordx4 v[144:147], v244, s[20:23], s53 offen offset:1024 sc1
    buffer_load_dwordx4 v[148:151], v244, s[20:23], s54 offen offset:1024 sc1
    buffer_load_dwordx4 v[152:155], v244, s[20:23], s55 offen offset:1024 sc1
    buffer_load_dwordx4 v[156:159], v244, s[20:23], s56 offen offset:1024 sc1
    buffer_load_dwordx4 v[160:163], v244, s[20:23], s57 offen offset:1024 sc1
    buffer_load_dwordx4 v[164:167], v244, s[20:23], s58 offen offset:1024 sc1
    ds_read_b128 v[224:227], v246 offset:8192
    ds_read_b128 v[228:231], v247 offset:8192
    ds_read_b128 v[232:235], v248 offset:8192
    ds_read_b128 v[236:239], v249 offset:8192
    s_waitcnt vmcnt(27)
    s_waitcnt lgkmcnt(3)
    v_mfma_f32_16x16x32_bf16 v[0:3], v[168:171], v[224:227], v[0:3]
    s_waitcnt lgkmcnt(2)
    v_mfma_f32_16x16x32_bf16 v[4:7], v[168:171], v[228:231], v[4:7]
    s_waitcnt lgkmcnt(1)
    v_mfma_f32_16x16x32_bf16 v[8:11], v[168:171], v[232:235], v[8:11]
    s_waitcnt lgkmcnt(0)
    v_mfma_f32_16x16x32_bf16 v[12:15], v[168:171], v[236:239], v[12:15]
    buffer_load_dwordx4 v[168:171], v244, s[20:23], s52 offen offset:2048 sc1
    s_waitcnt vmcnt(27)
    v_mfma_f32_16x16x32_bf16 v[16:19], v[172:175], v[224:227], v[16:19]
    v_mfma_f32_16x16x32_bf16 v[20:23], v[172:175], v[228:231], v[20:23]
    v_mfma_f32_16x16x32_bf16 v[24:27], v[172:175], v[232:235], v[24:27]
    v_mfma_f32_16x16x32_bf16 v[28:31], v[172:175], v[236:239], v[28:31]
    buffer_load_dwordx4 v[172:175], v244, s[20:23], s53 offen offset:2048 sc1
    s_waitcnt vmcnt(27)
    v_mfma_f32_16x16x32_bf16 v[32:35], v[176:179], v[224:227], v[32:35]
    v_mfma_f32_16x16x32_bf16 v[36:39], v[176:179], v[228:231], v[36:39]
    v_mfma_f32_16x16x32_bf16 v[40:43], v[176:179], v[232:235], v[40:43]
    v_mfma_f32_16x16x32_bf16 v[44:47], v[176:179], v[236:239], v[44:47]
    buffer_load_dwordx4 v[176:179], v244, s[20:23], s54 offen offset:2048 sc1
    s_waitcnt vmcnt(27)
    v_mfma_f32_16x16x32_bf16 v[48:51], v[180:183], v[224:227], v[48:51]
    v_mfma_f32_16x16x32_bf16 v[52:55], v[180:183], v[228:231], v[52:55]
    v_mfma_f32_16x16x32_bf16 v[56:59], v[180:183], v[232:235], v[56:59]
    v_mfma_f32_16x16x32_bf16 v[60:63], v[180:183], v[236:239], v[60:63]
    buffer_load_dwordx4 v[180:183], v244, s[20:23], s55 offen offset:2048 sc1
    s_waitcnt vmcnt(27)
    v_mfma_f32_16x16x32_bf16 v[64:67], v[184:187], v[224:227], v[64:67]
    v_mfma_f32_16x16x32_bf16 v[68:71], v[184:187], v[228:231], v[68:71]
    v_mfma_f32_16x16x32_bf16 v[72:75], v[184:187], v[232:235], v[72:75]
    v_mfma_f32_16x16x32_bf16 v[76:79], v[184:187], v[236:239], v[76:79]
    buffer_load_dwordx4 v[184:187], v244, s[20:23], s56 offen offset:2048 sc1
    s_waitcnt vmcnt(27)
    v_mfma_f32_16x16x32_bf16 v[80:83], v[188:191], v[224:227], v[80:83]
    v_mfma_f32_16x16x32_bf16 v[84:87], v[188:191], v[228:231], v[84:87]
    v_mfma_f32_16x16x32_bf16 v[88:91], v[188:191], v[232:235], v[88:91]
    v_mfma_f32_16x16x32_bf16 v[92:95], v[188:191], v[236:239], v[92:95]
    buffer_load_dwordx4 v[188:191], v244, s[20:23], s57 offen offset:2048 sc1
    s_waitcnt vmcnt(27)
    v_mfma_f32_16x16x32_bf16 v[96:99], v[192:195], v[224:227], v[96:99]
    v_mfma_f32_16x16x32_bf16 v[100:103], v[192:195], v[228:231], v[100:103]
    v_mfma_f32_16x16x32_bf16 v[104:107], v[192:195], v[232:235], v[104:107]
    v_mfma_f32_16x16x32_bf16 v[108:111], v[192:195], v[236:239], v[108:111]
    buffer_load_dwordx4 v[192:195], v244, s[20:23], s58 offen offset:2048 sc1
    ds_read_b128 v[224:227], v250 offset:8192
    ds_read_b128 v[228:231], v251 offset:8192
    ds_read_b128 v[232:235], v252 offset:8192
    ds_read_b128 v[236:239], v253 offset:8192
    s_waitcnt vmcnt(20)
    s_waitcnt lgkmcnt(3)
    v_mfma_f32_16x16x32_bf16 v[0:3], v[196:199], v[224:227], v[0:3]
    s_waitcnt lgkmcnt(2)
    v_mfma_f32_16x16x32_bf16 v[4:7], v[196:199], v[228:231], v[4:7]
    s_waitcnt lgkmcnt(1)
    v_mfma_f32_16x16x32_bf16 v[8:11], v[196:199], v[232:235], v[8:11]
    s_waitcnt lgkmcnt(0)
    v_mfma_f32_16x16x32_bf16 v[12:15], v[196:199], v[236:239], v[12:15]
    buffer_load_dwordx4 v[196:199], v244, s[20:23], s52 offen offset:3072 sc1
    s_add_u32 m0, s39, 8192
    s_nop 0
    buffer_load_dwordx4 v242, s[16:19], s48 offen lds
    buffer_load_dwordx4 v243, s[16:19], s48 offen offset:1024 lds
    s_add_u32 s48, s48, 128
    s_waitcnt vmcnt(22)
    v_mfma_f32_16x16x32_bf16 v[16:19], v[200:203], v[224:227], v[16:19]
    v_mfma_f32_16x16x32_bf16 v[20:23], v[200:203], v[228:231], v[20:23]
    v_mfma_f32_16x16x32_bf16 v[24:27], v[200:203], v[232:235], v[24:27]
    v_mfma_f32_16x16x32_bf16 v[28:31], v[200:203], v[236:239], v[28:31]
    buffer_load_dwordx4 v[200:203], v244, s[20:23], s53 offen offset:3072 sc1
    s_waitcnt vmcnt(22)
    v_mfma_f32_16x16x32_bf16 v[32:35], v[204:207], v[224:227], v[32:35]
    v_mfma_f32_16x16x32_bf16 v[36:39], v[204:207], v[228:231], v[36:39]
    v_mfma_f32_16x16x32_bf16 v[40:43], v[204:207], v[232:235], v[40:43]
    v_mfma_f32_16x16x32_bf16 v[44:47], v[204:207], v[236:239], v[44:47]
    buffer_load_dwordx4 v[204:207], v244, s[20:23], s54 offen offset:3072 sc1
    s_add_u32 m0, s39, 10240
    s_nop 0
    buffer_load_dwordx4 v242, s[16:19], s49 offen lds
    buffer_load_dwordx4 v243, s[16:19], s49 offen offset:1024 lds
    s_add_u32 s49, s49, 128
    s_waitcnt vmcnt(24)
    v_mfma_f32_16x16x32_bf16 v[48:51], v[208:211], v[224:227], v[48:51]
    v_mfma_f32_16x16x32_bf16 v[52:55], v[208:211], v[228:231], v[52:55]
    v_mfma_f32_16x16x32_bf16 v[56:59], v[208:211], v[232:235], v[56:59]
    v_mfma_f32_16x16x32_bf16 v[60:63], v[208:211], v[236:239], v[60:63]
    buffer_load_dwordx4 v[208:211], v244, s[20:23], s55 offen offset:3072 sc1
    s_waitcnt vmcnt(24)
    v_mfma_f32_16x16x32_bf16 v[64:67], v[212:215], v[224:227], v[64:67]
    v_mfma_f32_16x16x32_bf16 v[68:71], v[212:215], v[228:231], v[68:71]
    v_mfma_f32_16x16x32_bf16 v[72:75], v[212:215], v[232:235], v[72:75]
    v_mfma_f32_16x16x32_bf16 v[76:79], v[212:215], v[236:239], v[76:79]
    buffer_load_dwordx4 v[212:215], v244, s[20:23], s56 offen offset:3072 sc1
    s_add_u32 m0, s39, 12288
    s_nop 0
    buffer_load_dwordx4 v242, s[16:19], s50 offen lds
    buffer_load_dwordx4 v243, s[16:19], s50 offen offset:1024 lds
    s_add_u32 s50, s50, 128
    s_waitcnt vmcnt(26)
    v_mfma_f32_16x16x32_bf16 v[80:83], v[216:219], v[224:227], v[80:83]
    v_mfma_f32_16x16x32_bf16 v[84:87], v[216:219], v[228:231], v[84:87]
    v_mfma_f32_16x16x32_bf16 v[88:91], v[216:219], v[232:235], v[88:91]
    v_mfma_f32_16x16x32_bf16 v[92:95], v[216:219], v[236:239], v[92:95]
    buffer_load_dwordx4 v[216:219], v244, s[20:23], s57 offen offset:3072 sc1
    s_waitcnt vmcnt(26)
    v_mfma_f32_16x16x32_bf16 v[96:99], v[220:223], v[224:227], v[96:99]
    v_mfma_f32_16x16x32_bf16 v[100:103], v[220:223], v[228:231], v[100:103]
    v_mfma_f32_16x16x32_bf16 v[104:107], v[220:223], v[232:235], v[104:107]
    v_mfma_f32_16x16x32_bf16 v[108:111], v[220:223], v[236:239], v[108:111]
    buffer_load_dwordx4 v[220:223], v244, s[20:23], s58 offen offset:3072 sc1
    s_add_u32 m0, s39, 14336
    s_nop 0
    buffer_load_dwordx4 v242, s[16:19], s51 offen lds
    buffer_load_dwordx4 v243, s[16:19], s51 offen offset:1024 lds
    s_add_u32 s51, s51, 128
    v_add_u32 v246, s59, v246
    v_add_u32 v247, s59, v247
    v_add_u32 v248, s59, v248
    v_add_u32 v249, s59, v249
    ds_read_b128 v[224:227], v246 offset:0
    ds_read_b128 v[228:231], v247 offset:0
    ds_read_b128 v[232:235], v248 offset:0
    ds_read_b128 v[236:239], v249 offset:0
    v_subrev_u32 v246, s59, v246
    v_subrev_u32 v247, s59, v247
    v_subrev_u32 v248, s59, v248
    v_subrev_u32 v249, s59, v249
    s_waitcnt lgkmcnt(3)
    v_mfma_f32_16x16x32_bf16 v[0:3], v[112:115], v[224:227], v[0:3]
    s_waitcnt lgkmcnt(2)
    v_mfma_f32_16x16x32_bf16 v[4:7], v[112:115], v[228:231], v[4:7]
    s_waitcnt lgkmcnt(1)
    v_mfma_f32_16x16x32_bf16 v[8:11], v[112:115], v[232:235], v[8:11]
    s_waitcnt lgkmcnt(0)
    v_mfma_f32_16x16x32_bf16 v[12:15], v[112:115], v[236:239], v[12:15]
    s_add_u32 s52, s52, 4096
    buffer_load_dwordx4 v[112:115], v244, s[20:23], s52 offen offset:0 sc1
    v_mfma_f32_16x16x32_bf16 v[16:19], v[116:119], v[224:227], v[16:19]
    v_mfma_f32_16x16x32_bf16 v[20:23], v[116:119], v[228:231], v[20:23]
    v_mfma_f32_16x16x32_bf16 v[24:27], v[116:119], v[232:235], v[24:27]
    v_mfma_f32_16x16x32_bf16 v[28:31], v[116:119], v[236:239], v[28:31]
    s_add_u32 s53, s53, 4096
    buffer_load_dwordx4 v[116:119], v244, s[20:23], s53 offen offset:0 sc1
    v_mfma_f32_16x16x32_bf16 v[32:35], v[120:123], v[224:227], v[32:35]
    v_mfma_f32_16x16x32_bf16 v[36:39], v[120:123], v[228:231], v[36:39]
    v_mfma_f32_16x16x32_bf16 v[40:43], v[120:123], v[232:235], v[40:43]
    v_mfma_f32_16x16x32_bf16 v[44:47], v[120:123], v[236:239], v[44:47]
    s_add_u32 s54, s54, 4096
    buffer_load_dwordx4 v[120:123], v244, s[20:23], s54 offen offset:0 sc1
    v_mfma_f32_16x16x32_bf16 v[48:51], v[124:127], v[224:227], v[48:51]
    v_mfma_f32_16x16x32_bf16 v[52:55], v[124:127], v[228:231], v[52:55]
    v_mfma_f32_16x16x32_bf16 v[56:59], v[124:127], v[232:235], v[56:59]
    v_mfma_f32_16x16x32_bf16 v[60:63], v[124:127], v[236:239], v[60:63]
    s_add_u32 s55, s55, 4096
    buffer_load_dwordx4 v[124:127], v244, s[20:23], s55 offen offset:0 sc1
    v_mfma_f32_16x16x32_bf16 v[64:67], v[128:131], v[224:227], v[64:67]
    v_mfma_f32_16x16x32_bf16 v[68:71], v[128:131], v[228:231], v[68:71]
    v_mfma_f32_16x16x32_bf16 v[72:75], v[128:131], v[232:235], v[72:75]
    v_mfma_f32_16x16x32_bf16 v[76:79], v[128:131], v[236:239], v[76:79]
    s_add_u32 s56, s56, 4096
    buffer_load_dwordx4 v[128:131], v244, s[20:23], s56 offen offset:0 sc1
    v_mfma_f32_16x16x32_bf16 v[80:83], v[132:135], v[224:227], v[80:83]
    v_mfma_f32_16x16x32_bf16 v[84:87], v[132:135], v[228:231], v[84:87]
    v_mfma_f32_16x16x32_bf16 v[88:91], v[132:135], v[232:235], v[88:91]
    v_mfma_f32_16x16x32_bf16 v[92:95], v[132:135], v[236:239], v[92:95]
    s_add_u32 s57, s57, 4096
    buffer_load_dwordx4 v[132:135], v244, s[20:23], s57 offen offset:0 sc1
    v_mfma_f32_16x16x32_bf16 v[96:99], v[136:139], v[224:227], v[96:99]
    v_mfma_f32_16x16x32_bf16 v[100:103], v[136:139], v[228:231], v[100:103]
    v_mfma_f32_16x16x32_bf16 v[104:107], v[136:139], v[232:235], v[104:107]
    v_mfma_f32_16x16x32_bf16 v[108:111], v[136:139], v[236:239], v[108:111]
    s_add_u32 s58, s58, 4096
    buffer_load_dwordx4 v[136:139], v244, s[20:23], s58 offen offset:0 sc1
    v_add_u32 v250, s59, v250
    v_add_u32 v251, s59, v251
    v_add_u32 v252, s59, v252
    v_add_u32 v253, s59, v253
    ds_read_b128 v[224:227], v250 offset:0
    ds_read_b128 v[228:231], v251 offset:0
    ds_read_b128 v[232:235], v252 offset:0
    ds_read_b128 v[236:239], v253 offset:0
    v_subrev_u32 v250, s59, v250
    v_subrev_u32 v251, s59, v251
    v_subrev_u32 v252, s59, v252
    v_subrev_u32 v253, s59, v253
    s_waitcnt vmcnt(35)
    s_waitcnt lgkmcnt(3)
    v_mfma_f32_16x16x32_bf16 v[0:3], v[140:143], v[224:227], v[0:3]
    s_waitcnt lgkmcnt(2)
    v_mfma_f32_16x16x32_bf16 v[4:7], v[140:143], v[228:231], v[4:7]
    s_waitcnt lgkmcnt(1)
    v_mfma_f32_16x16x32_bf16 v[8:11], v[140:143], v[232:235], v[8:11]
    s_waitcnt lgkmcnt(0)
    v_mfma_f32_16x16x32_bf16 v[12:15], v[140:143], v[236:239], v[12:15]
    buffer_load_dwordx4 v[140:143], v244, s[20:23], s52 offen offset:1024 sc1
    s_add_u32 m0, s38, 0
    s_nop 0
    buffer_load_dwordx4 v242, s[16:19], s48 offen lds
    buffer_load_dwordx4 v243, s[16:19], s48 offen offset:1024 lds
    s_add_u32 s48, s48, 128
    s_waitcnt vmcnt(37)
    v_mfma_f32_16x16x32_bf16 v[16:19], v[144:147], v[224:227], v[16:19]
    v_mfma_f32_16x16x32_bf16 v[20:23], v[144:147], v[228:231], v[20:23]
    v_mfma_f32_16x16x32_bf16 v[24:27], v[144:147], v[232:235], v[24:27]
    v_mfma_f32_16x16x32_bf16 v[28:31], v[144:147], v[236:239], v[28:31]
    buffer_load_dwordx4 v[144:147], v244, s[20:23], s53 offen offset:1024 sc1
    s_waitcnt vmcnt(37)
    v_mfma_f32_16x16x32_bf16 v[32:35], v[148:151], v[224:227], v[32:35]
    v_mfma_f32_16x16x32_bf16 v[36:39], v[148:151], v[228:231], v[36:39]
    v_mfma_f32_16x16x32_bf16 v[40:43], v[148:151], v[232:235], v[40:43]
    v_mfma_f32_16x16x32_bf16 v[44:47], v[148:151], v[236:239], v[44:47]
    buffer_load_dwordx4 v[148:151], v244, s[20:23], s54 offen offset:1024 sc1
    s_add_u32 m0, s38, 2048
    s_nop 0
    buffer_load_dwordx4 v242, s[16:19], s49 offen lds
    buffer_load_dwordx4 v243, s[16:19], s49 offen offset:1024 lds
    s_add_u32 s49, s49, 128
    s_waitcnt vmcnt(39)
    v_mfma_f32_16x16x32_bf16 v[48:51], v[152:155], v[224:227], v[48:51]
    v_mfma_f32_16x16x32_bf16 v[52:55], v[152:155], v[228:231], v[52:55]
    v_mfma_f32_16x16x32_bf16 v[56:59], v[152:155], v[232:235], v[56:59]
    v_mfma_f32_16x16x32_bf16 v[60:63], v[152:155], v[236:239], v[60:63]
    buffer_load_dwordx4 v[152:155], v244, s[20:23], s55 offen offset:1024 sc1
    s_waitcnt vmcnt(39)
    v_mfma_f32_16x16x32_bf16 v[64:67], v[156:159], v[224:227], v[64:67]
    v_mfma_f32_16x16x32_bf16 v[68:71], v[156:159], v[228:231], v[68:71]
    v_mfma_f32_16x16x32_bf16 v[72:75], v[156:159], v[232:235], v[72:75]
    v_mfma_f32_16x16x32_bf16 v[76:79], v[156:159], v[236:239], v[76:79]
    buffer_load_dwordx4 v[156:159], v244, s[20:23], s56 offen offset:1024 sc1
    s_add_u32 m0, s38, 4096
    s_nop 0
    buffer_load_dwordx4 v242, s[16:19], s50 offen lds
    buffer_load_dwordx4 v243, s[16:19], s50 offen offset:1024 lds
    s_add_u32 s50, s50, 128
    s_waitcnt vmcnt(41)
    v_mfma_f32_16x16x32_bf16 v[80:83], v[160:163], v[224:227], v[80:83]
    v_mfma_f32_16x16x32_bf16 v[84:87], v[160:163], v[228:231], v[84:87]
    v_mfma_f32_16x16x32_bf16 v[88:91], v[160:163], v[232:235], v[88:91]
    v_mfma_f32_16x16x32_bf16 v[92:95], v[160:163], v[236:239], v[92:95]
    buffer_load_dwordx4 v[160:163], v244, s[20:23], s57 offen offset:1024 sc1
    s_waitcnt vmcnt(41)
    v_mfma_f32_16x16x32_bf16 v[96:99], v[164:167], v[224:227], v[96:99]
    v_mfma_f32_16x16x32_bf16 v[100:103], v[164:167], v[228:231], v[100:103]
    v_mfma_f32_16x16x32_bf16 v[104:107], v[164:167], v[232:235], v[104:107]
    v_mfma_f32_16x16x32_bf16 v[108:111], v[164:167], v[236:239], v[108:111]
    buffer_load_dwordx4 v[164:167], v244, s[20:23], s58 offen offset:1024 sc1
    s_add_u32 m0, s38, 6144
    s_nop 0
    buffer_load_dwordx4 v242, s[16:19], s51 offen lds
    buffer_load_dwordx4 v243, s[16:19], s51 offen offset:1024 lds
    s_add_u32 s51, s51, 128
    ds_read_b128 v[224:227], v246 offset:0
    ds_read_b128 v[228:231], v247 offset:0
    ds_read_b128 v[232:235], v248 offset:0
    ds_read_b128 v[236:239], v249 offset:0
    s_waitcnt vmcnt(43)
    s_waitcnt lgkmcnt(3)
    v_mfma_f32_16x16x32_bf16 v[0:3], v[168:171], v[224:227], v[0:3]
    s_waitcnt lgkmcnt(2)
    v_mfma_f32_16x16x32_bf16 v[4:7], v[168:171], v[228:231], v[4:7]
    s_waitcnt lgkmcnt(1)
    v_mfma_f32_16x16x32_bf16 v[8:11], v[168:171], v[232:235], v[8:11]
    s_waitcnt lgkmcnt(0)
    v_mfma_f32_16x16x32_bf16 v[12:15], v[168:171], v[236:239], v[12:15]
    buffer_load_dwordx4 v[168:171], v244, s[20:23], s52 offen offset:2048 sc1
    s_waitcnt vmcnt(43)
    v_mfma_f32_16x16x32_bf16 v[16:19], v[172:175], v[224:227], v[16:19]
    v_mfma_f32_16x16x32_bf16 v[20:23], v[172:175], v[228:231], v[20:23]
    v_mfma_f32_16x16x32_bf16 v[24:27], v[172:175], v[232:235], v[24:27]
    v_mfma_f32_16x16x32_bf16 v[28:31], v[172:175], v[236:239], v[28:31]
    buffer_load_dwordx4 v[172:175], v244, s[20:23], s53 offen offset:2048 sc1
    s_waitcnt vmcnt(43)
    v_mfma_f32_16x16x32_bf16 v[32:35], v[176:179], v[224:227], v[32:35]
    v_mfma_f32_16x16x32_bf16 v[36:39], v[176:179], v[228:231], v[36:39]
    v_mfma_f32_16x16x32_bf16 v[40:43], v[176:179], v[232:235], v[40:43]
    v_mfma_f32_16x16x32_bf16 v[44:47], v[176:179], v[236:239], v[44:47]
    buffer_load_dwordx4 v[176:179], v244, s[20:23], s54 offen offset:2048 sc1
    s_waitcnt vmcnt(43)
    v_mfma_f32_16x16x32_bf16 v[48:51], v[180:183], v[224:227], v[48:51]
    v_mfma_f32_16x16x32_bf16 v[52:55], v[180:183], v[228:231], v[52:55]
    v_mfma_f32_16x16x32_bf16 v[56:59], v[180:183], v[232:235], v[56:59]
    v_mfma_f32_16x16x32_bf16 v[60:63], v[180:183], v[236:239], v[60:63]
    buffer_load_dwordx4 v[180:183], v244, s[20:23], s55 offen offset:2048 sc1
    s_waitcnt vmcnt(43)
    v_mfma_f32_16x16x32_bf16 v[64:67], v[184:187], v[224:227], v[64:67]
    v_mfma_f32_16x16x32_bf16 v[68:71], v[184:187], v[228:231], v[68:71]
    v_mfma_f32_16x16x32_bf16 v[72:75], v[184:187], v[232:235], v[72:75]
    v_mfma_f32_16x16x32_bf16 v[76:79], v[184:187], v[236:239], v[76:79]
    buffer_load_dwordx4 v[184:187], v244, s[20:23], s56 offen offset:2048 sc1
    s_waitcnt vmcnt(43)
    v_mfma_f32_16x16x32_bf16 v[80:83], v[188:191], v[224:227], v[80:83]
    v_mfma_f32_16x16x32_bf16 v[84:87], v[188:191], v[228:231], v[84:87]
    v_mfma_f32_16x16x32_bf16 v[88:91], v[188:191], v[232:235], v[88:91]
    v_mfma_f32_16x16x32_bf16 v[92:95], v[188:191], v[236:239], v[92:95]
    buffer_load_dwordx4 v[188:191], v244, s[20:23], s57 offen offset:2048 sc1
    s_waitcnt vmcnt(43)
    v_mfma_f32_16x16x32_bf16 v[96:99], v[192:195], v[224:227], v[96:99]
    v_mfma_f32_16x16x32_bf16 v[100:103], v[192:195], v[228:231], v[100:103]
    v_mfma_f32_16x16x32_bf16 v[104:107], v[192:195], v[232:235], v[104:107]
    v_mfma_f32_16x16x32_bf16 v[108:111], v[192:195], v[236:239], v[108:111]
    buffer_load_dwordx4 v[192:195], v244, s[20:23], s58 offen offset:2048 sc1
    ds_read_b128 v[224:227], v250 offset:0
    ds_read_b128 v[228:231], v251 offset:0
    ds_read_b128 v[232:235], v252 offset:0
    ds_read_b128 v[236:239], v253 offset:0
    s_waitcnt vmcnt(43)
    s_waitcnt lgkmcnt(3)
    v_mfma_f32_16x16x32_bf16 v[0:3], v[196:199], v[224:227], v[0:3]
    s_waitcnt lgkmcnt(2)
    v_mfma_f32_16x16x32_bf16 v[4:7], v[196:199], v[228:231], v[4:7]
    s_waitcnt lgkmcnt(1)
    v_mfma_f32_16x16x32_bf16 v[8:11], v[196:199], v[232:235], v[8:11]
    s_waitcnt lgkmcnt(0)
    v_mfma_f32_16x16x32_bf16 v[12:15], v[196:199], v[236:239], v[12:15]
    buffer_load_dwordx4 v[196:199], v244, s[20:23], s52 offen offset:3072 sc1
    s_add_u32 m0, s39, 0
    s_nop 0
    buffer_load_dwordx4 v242, s[16:19], s48 offen lds
    buffer_load_dwordx4 v243, s[16:19], s48 offen offset:1024 lds
    s_add_u32 s48, s48, 128
    s_waitcnt vmcnt(43)
    v_mfma_f32_16x16x32_bf16 v[16:19], v[200:203], v[224:227], v[16:19]
    v_mfma_f32_16x16x32_bf16 v[20:23], v[200:203], v[228:231], v[20:23]
    v_mfma_f32_16x16x32_bf16 v[24:27], v[200:203], v[232:235], v[24:27]
    v_mfma_f32_16x16x32_bf16 v[28:31], v[200:203], v[236:239], v[28:31]
    buffer_load_dwordx4 v[200:203], v244, s[20:23], s53 offen offset:3072 sc1
    s_waitcnt vmcnt(43)
    v_mfma_f32_16x16x32_bf16 v[32:35], v[204:207], v[224:227], v[32:35]
    v_mfma_f32_16x16x32_bf16 v[36:39], v[204:207], v[228:231], v[36:39]
    v_mfma_f32_16x16x32_bf16 v[40:43], v[204:207], v[232:235], v[40:43]
    v_mfma_f32_16x16x32_bf16 v[44:47], v[204:207], v[236:239], v[44:47]
    buffer_load_dwordx4 v[204:207], v244, s[20:23], s54 offen offset:3072 sc1
    s_add_u32 m0, s39, 2048
    s_nop 0
    buffer_load_dwordx4 v242, s[16:19], s49 offen lds
    buffer_load_dwordx4 v243, s[16:19], s49 offen offset:1024 lds
    s_add_u32 s49, s49, 128
    s_waitcnt vmcnt(43)
    v_mfma_f32_16x16x32_bf16 v[48:51], v[208:211], v[224:227], v[48:51]
    v_mfma_f32_16x16x32_bf16 v[52:55], v[208:211], v[228:231], v[52:55]
    v_mfma_f32_16x16x32_bf16 v[56:59], v[208:211], v[232:235], v[56:59]
    v_mfma_f32_16x16x32_bf16 v[60:63], v[208:211], v[236:239], v[60:63]
    buffer_load_dwordx4 v[208:211], v244, s[20:23], s55 offen offset:3072 sc1
    s_waitcnt vmcnt(43)
    v_mfma_f32_16x16x32_bf16 v[64:67], v[212:215], v[224:227], v[64:67]
    v_mfma_f32_16x16x32_bf16 v[68:71], v[212:215], v[228:231], v[68:71]
    v_mfma_f32_16x16x32_bf16 v[72:75], v[212:215], v[232:235], v[72:75]
    v_mfma_f32_16x16x32_bf16 v[76:79], v[212:215], v[236:239], v[76:79]
    buffer_load_dwordx4 v[212:215], v244, s[20:23], s56 offen offset:3072 sc1
    s_add_u32 m0, s39, 4096
    s_nop 0
    buffer_load_dwordx4 v242, s[16:19], s50 offen lds
    buffer_load_dwordx4 v243, s[16:19], s50 offen offset:1024 lds
    s_add_u32 s50, s50, 128
    s_waitcnt vmcnt(43)
    v_mfma_f32_16x16x32_bf16 v[80:83], v[216:219], v[224:227], v[80:83]
    v_mfma_f32_16x16x32_bf16 v[84:87], v[216:219], v[228:231], v[84:87]
    v_mfma_f32_16x16x32_bf16 v[88:91], v[216:219], v[232:235], v[88:91]
    v_mfma_f32_16x16x32_bf16 v[92:95], v[216:219], v[236:239], v[92:95]
    buffer_load_dwordx4 v[216:219], v244, s[20:23], s57 offen offset:3072 sc1
    s_waitcnt vmcnt(43)
    v_mfma_f32_16x16x32_bf16 v[96:99], v[220:223], v[224:227], v[96:99]
    v_mfma_f32_16x16x32_bf16 v[100:103], v[220:223], v[228:231], v[100:103]
    v_mfma_f32_16x16x32_bf16 v[104:107], v[220:223], v[232:235], v[104:107]
    v_mfma_f32_16x16x32_bf16 v[108:111], v[220:223], v[236:239], v[108:111]
    buffer_load_dwordx4 v[220:223], v244, s[20:23], s58 offen offset:3072 sc1
    s_add_u32 m0, s39, 6144
    s_nop 0
    buffer_load_dwordx4 v242, s[16:19], s51 offen lds
    buffer_load_dwordx4 v243, s[16:19], s51 offen offset:1024 lds
    s_add_u32 s51, s51, 128
    s_waitcnt vmcnt(44)
    ds_read_b128 v[224:227], v246 offset:8192
    ds_read_b128 v[228:231], v247 offset:8192
    ds_read_b128 v[232:235], v248 offset:8192
    ds_read_b128 v[236:239], v249 offset:8192
    s_waitcnt vmcnt(43)
    s_waitcnt lgkmcnt(3)
    v_mfma_f32_16x16x32_bf16 v[0:3], v[112:115], v[224:227], v[0:3]
    s_waitcnt lgkmcnt(2)
    v_mfma_f32_16x16x32_bf16 v[4:7], v[112:115], v[228:231], v[4:7]
    s_waitcnt lgkmcnt(1)
    v_mfma_f32_16x16x32_bf16 v[8:11], v[112:115], v[232:235], v[8:11]
    s_waitcnt lgkmcnt(0)
    v_mfma_f32_16x16x32_bf16 v[12:15], v[112:115], v[236:239], v[12:15]
    s_add_u32 s52, s52, 4096
    buffer_load_dwordx4 v[112:115], v244, s[20:23], s52 offen offset:0 sc1
    s_waitcnt vmcnt(43)
    v_mfma_f32_16x16x32_bf16 v[16:19], v[116:119], v[224:227], v[16:19]
    v_mfma_f32_16x16x32_bf16 v[20:23], v[116:119], v[228:231], v[20:23]
    v_mfma_f32_16x16x32_bf16 v[24:27], v[116:119], v[232:235], v[24:27]
    v_mfma_f32_16x16x32_bf16 v[28:31], v[116:119], v[236:239], v[28:31]
    s_add_u32 s53, s53, 4096
    buffer_load_dwordx4 v[116:119], v244, s[20:23], s53 offen offset:0 sc1
    s_waitcnt vmcnt(43)
    v_mfma_f32_16x16x32_bf16 v[32:35], v[120:123], v[224:227], v[32:35]
    v_mfma_f32_16x16x32_bf16 v[36:39], v[120:123], v[228:231], v[36:39]
    v_mfma_f32_16x16x32_bf16 v[40:43], v[120:123], v[232:235], v[40:43]
    v_mfma_f32_16x16x32_bf16 v[44:47], v[120:123], v[236:239], v[44:47]
    s_add_u32 s54, s54, 4096
    buffer_load_dwordx4 v[120:123], v244, s[20:23], s54 offen offset:0 sc1
    s_waitcnt vmcnt(43)
    v_mfma_f32_16x16x32_bf16 v[48:51], v[124:127], v[224:227], v[48:51]
    v_mfma_f32_16x16x32_bf16 v[52:55], v[124:127], v[228:231], v[52:55]
    v_mfma_f32_16x16x32_bf16 v[56:59], v[124:127], v[232:235], v[56:59]
    v_mfma_f32_16x16x32_bf16 v[60:63], v[124:127], v[236:239], v[60:63]
    s_add_u32 s55, s55, 4096
    buffer_load_dwordx4 v[124:127], v244, s[20:23], s55 offen offset:0 sc1
    s_waitcnt vmcnt(43)
    v_mfma_f32_16x16x32_bf16 v[64:67], v[128:131], v[224:227], v[64:67]
    v_mfma_f32_16x16x32_bf16 v[68:71], v[128:131], v[228:231], v[68:71]
    v_mfma_f32_16x16x32_bf16 v[72:75], v[128:131], v[232:235], v[72:75]
    v_mfma_f32_16x16x32_bf16 v[76:79], v[128:131], v[236:239], v[76:79]
    s_add_u32 s56, s56, 4096
    buffer_load_dwordx4 v[128:131], v244, s[20:23], s56 offen offset:0 sc1
    s_waitcnt vmcnt(43)
    v_mfma_f32_16x16x32_bf16 v[80:83], v[132:135], v[224:227], v[80:83]
    v_mfma_f32_16x16x32_bf16 v[84:87], v[132:135], v[228:231], v[84:87]
    v_mfma_f32_16x16x32_bf16 v[88:91], v[132:135], v[232:235], v[88:91]
    v_mfma_f32_16x16x32_bf16 v[92:95], v[132:135], v[236:239], v[92:95]
    s_add_u32 s57, s57, 4096
    buffer_load_dwordx4 v[132:135], v244, s[20:23], s57 offen offset:0 sc1
    s_waitcnt vmcnt(43)
    v_mfma_f32_16x16x32_bf16 v[96:99], v[136:139], v[224:227], v[96:99]
    v_mfma_f32_16x16x32_bf16 v[100:103], v[136:139], v[228:231], v[100:103]
    v_mfma_f32_16x16x32_bf16 v[104:107], v[136:139], v[232:235], v[104:107]
    v_mfma_f32_16x16x32_bf16 v[108:111], v[136:139], v[236:239], v[108:111]
    s_add_u32 s58, s58, 4096
    buffer_load_dwordx4 v[136:139], v244, s[20:23], s58 offen offset:0 sc1
    s_lshl_b32 s43, s33, 2
    s_add_u32 s43, s43, 163728
    v_mov_b32 v254, s43
    v_mov_b32 v255, 1
    ds_write_b32 v254, v255
    ds_read_b128 v[224:227], v250 offset:8192
    ds_read_b128 v[228:231], v251 offset:8192
    ds_read_b128 v[232:235], v252 offset:8192
    ds_read_b128 v[236:239], v253 offset:8192
    s_waitcnt vmcnt(43)
    s_waitcnt lgkmcnt(3)
    v_mfma_f32_16x16x32_bf16 v[0:3], v[140:143], v[224:227], v[0:3]
    s_waitcnt lgkmcnt(2)
    v_mfma_f32_16x16x32_bf16 v[4:7], v[140:143], v[228:231], v[4:7]
    s_waitcnt lgkmcnt(1)
    v_mfma_f32_16x16x32_bf16 v[8:11], v[140:143], v[232:235], v[8:11]
    s_waitcnt lgkmcnt(0)
    v_mfma_f32_16x16x32_bf16 v[12:15], v[140:143], v[236:239], v[12:15]
    buffer_load_dwordx4 v[140:143], v244, s[20:23], s52 offen offset:1024 sc1
    s_add_u32 m0, s39, 8192
    s_nop 0
    buffer_load_dwordx4 v242, s[16:19], s48 offen lds
    buffer_load_dwordx4 v243, s[16:19], s48 offen offset:1024 lds
    s_add_u32 s48, s48, 128
    s_waitcnt vmcnt(43)
    v_mfma_f32_16x16x32_bf16 v[16:19], v[144:147], v[224:227], v[16:19]
    v_mfma_f32_16x16x32_bf16 v[20:23], v[144:147], v[228:231], v[20:23]
    v_mfma_f32_16x16x32_bf16 v[24:27], v[144:147], v[232:235], v[24:27]
    v_mfma_f32_16x16x32_bf16 v[28:31], v[144:147], v[236:239], v[28:31]
    buffer_load_dwordx4 v[144:147], v244, s[20:23], s53 offen offset:1024 sc1
    s_waitcnt vmcnt(43)
    v_mfma_f32_16x16x32_bf16 v[32:35], v[148:151], v[224:227], v[32:35]
    v_mfma_f32_16x16x32_bf16 v[36:39], v[148:151], v[228:231], v[36:39]
    v_mfma_f32_16x16x32_bf16 v[40:43], v[148:151], v[232:235], v[40:43]
    v_mfma_f32_16x16x32_bf16 v[44:47], v[148:151], v[236:239], v[44:47]
    buffer_load_dwordx4 v[148:151], v244, s[20:23], s54 offen offset:1024 sc1
    s_add_u32 m0, s39, 10240
    s_nop 0
    buffer_load_dwordx4 v242, s[16:19], s49 offen lds
    buffer_load_dwordx4 v243, s[16:19], s49 offen offset:1024 lds
    s_add_u32 s49, s49, 128
    s_waitcnt vmcnt(43)
    v_mfma_f32_16x16x32_bf16 v[48:51], v[152:155], v[224:227], v[48:51]
    v_mfma_f32_16x16x32_bf16 v[52:55], v[152:155], v[228:231], v[52:55]
    v_mfma_f32_16x16x32_bf16 v[56:59], v[152:155], v[232:235], v[56:59]
    v_mfma_f32_16x16x32_bf16 v[60:63], v[152:155], v[236:239], v[60:63]
    buffer_load_dwordx4 v[152:155], v244, s[20:23], s55 offen offset:1024 sc1
    s_waitcnt vmcnt(43)
    v_mfma_f32_16x16x32_bf16 v[64:67], v[156:159], v[224:227], v[64:67]
    v_mfma_f32_16x16x32_bf16 v[68:71], v[156:159], v[228:231], v[68:71]
    v_mfma_f32_16x16x32_bf16 v[72:75], v[156:159], v[232:235], v[72:75]
    v_mfma_f32_16x16x32_bf16 v[76:79], v[156:159], v[236:239], v[76:79]
    buffer_load_dwordx4 v[156:159], v244, s[20:23], s56 offen offset:1024 sc1
    s_add_u32 m0, s39, 12288
    s_nop 0
    buffer_load_dwordx4 v242, s[16:19], s50 offen lds
    buffer_load_dwordx4 v243, s[16:19], s50 offen offset:1024 lds
    s_add_u32 s50, s50, 128
    s_waitcnt vmcnt(43)
    v_mfma_f32_16x16x32_bf16 v[80:83], v[160:163], v[224:227], v[80:83]
    v_mfma_f32_16x16x32_bf16 v[84:87], v[160:163], v[228:231], v[84:87]
    v_mfma_f32_16x16x32_bf16 v[88:91], v[160:163], v[232:235], v[88:91]
    v_mfma_f32_16x16x32_bf16 v[92:95], v[160:163], v[236:239], v[92:95]
    buffer_load_dwordx4 v[160:163], v244, s[20:23], s57 offen offset:1024 sc1
    s_waitcnt vmcnt(43)
    v_mfma_f32_16x16x32_bf16 v[96:99], v[164:167], v[224:227], v[96:99]
    v_mfma_f32_16x16x32_bf16 v[100:103], v[164:167], v[228:231], v[100:103]
    v_mfma_f32_16x16x32_bf16 v[104:107], v[164:167], v[232:235], v[104:107]
    v_mfma_f32_16x16x32_bf16 v[108:111], v[164:167], v[236:239], v[108:111]
    buffer_load_dwordx4 v[164:167], v244, s[20:23], s58 offen offset:1024 sc1
    s_add_u32 m0, s39, 14336
    s_nop 0
    buffer_load_dwordx4 v242, s[16:19], s51 offen lds
    buffer_load_dwordx4 v243, s[16:19], s51 offen offset:1024 lds
    s_add_u32 s51, s51, 128
    s_waitcnt vmcnt(44)
    v_add_u32 v246, s59, v246
    v_add_u32 v247, s59, v247
    v_add_u32 v248, s59, v248
    v_add_u32 v249, s59, v249
    ds_read_b128 v[224:227], v246 offset:0
    ds_read_b128 v[228:231], v247 offset:0
    ds_read_b128 v[232:235], v248 offset:0
    ds_read_b128 v[236:239], v249 offset:0
    v_subrev_u32 v246, s59, v246
    v_subrev_u32 v247, s59, v247
    v_subrev_u32 v248, s59, v248
    v_subrev_u32 v249, s59, v249
    s_waitcnt vmcnt(43)
    s_waitcnt lgkmcnt(3)
    v_mfma_f32_16x16x32_bf16 v[0:3], v[168:171], v[224:227], v[0:3]
    s_waitcnt lgkmcnt(2)
    v_mfma_f32_16x16x32_bf16 v[4:7], v[168:171], v[228:231], v[4:7]
    s_waitcnt lgkmcnt(1)
    v_mfma_f32_16x16x32_bf16 v[8:11], v[168:171], v[232:235], v[8:11]
    s_waitcnt lgkmcnt(0)
    v_mfma_f32_16x16x32_bf16 v[12:15], v[168:171], v[236:239], v[12:15]
    buffer_load_dwordx4 v[168:171], v244, s[20:23], s52 offen offset:2048 sc1
    s_waitcnt vmcnt(43)
    v_mfma_f32_16x16x32_bf16 v[16:19], v[172:175], v[224:227], v[16:19]
    v_mfma_f32_16x16x32_bf16 v[20:23], v[172:175], v[228:231], v[20:23]
    v_mfma_f32_16x16x32_bf16 v[24:27], v[172:175], v[232:235], v[24:27]
    v_mfma_f32_16x16x32_bf16 v[28:31], v[172:175], v[236:239], v[28:31]
    buffer_load_dwordx4 v[172:175], v244, s[20:23], s53 offen offset:2048 sc1
    s_waitcnt vmcnt(43)
    v_mfma_f32_16x16x32_bf16 v[32:35], v[176:179], v[224:227], v[32:35]
    v_mfma_f32_16x16x32_bf16 v[36:39], v[176:179], v[228:231], v[36:39]
    v_mfma_f32_16x16x32_bf16 v[40:43], v[176:179], v[232:235], v[40:43]
    v_mfma_f32_16x16x32_bf16 v[44:47], v[176:179], v[236:239], v[44:47]
    buffer_load_dwordx4 v[176:179], v244, s[20:23], s54 offen offset:2048 sc1
    s_waitcnt vmcnt(43)
    v_mfma_f32_16x16x32_bf16 v[48:51], v[180:183], v[224:227], v[48:51]
    v_mfma_f32_16x16x32_bf16 v[52:55], v[180:183], v[228:231], v[52:55]
    v_mfma_f32_16x16x32_bf16 v[56:59], v[180:183], v[232:235], v[56:59]
    v_mfma_f32_16x16x32_bf16 v[60:63], v[180:183], v[236:239], v[60:63]
    buffer_load_dwordx4 v[180:183], v244, s[20:23], s55 offen offset:2048 sc1
    s_waitcnt vmcnt(43)
    v_mfma_f32_16x16x32_bf16 v[64:67], v[184:187], v[224:227], v[64:67]
    v_mfma_f32_16x16x32_bf16 v[68:71], v[184:187], v[228:231], v[68:71]
    v_mfma_f32_16x16x32_bf16 v[72:75], v[184:187], v[232:235], v[72:75]
    v_mfma_f32_16x16x32_bf16 v[76:79], v[184:187], v[236:239], v[76:79]
    buffer_load_dwordx4 v[184:187], v244, s[20:23], s56 offen offset:2048 sc1
    s_waitcnt vmcnt(43)
    v_mfma_f32_16x16x32_bf16 v[80:83], v[188:191], v[224:227], v[80:83]
    v_mfma_f32_16x16x32_bf16 v[84:87], v[188:191], v[228:231], v[84:87]
    v_mfma_f32_16x16x32_bf16 v[88:91], v[188:191], v[232:235], v[88:91]
    v_mfma_f32_16x16x32_bf16 v[92:95], v[188:191], v[236:239], v[92:95]
    buffer_load_dwordx4 v[188:191], v244, s[20:23], s57 offen offset:2048 sc1
    s_waitcnt vmcnt(43)
    v_mfma_f32_16x16x32_bf16 v[96:99], v[192:195], v[224:227], v[96:99]
    v_mfma_f32_16x16x32_bf16 v[100:103], v[192:195], v[228:231], v[100:103]
    v_mfma_f32_16x16x32_bf16 v[104:107], v[192:195], v[232:235], v[104:107]
    v_mfma_f32_16x16x32_bf16 v[108:111], v[192:195], v[236:239], v[108:111]
    buffer_load_dwordx4 v[192:195], v244, s[20:23], s58 offen offset:2048 sc1
    v_add_u32 v250, s59, v250
    v_add_u32 v251, s59, v251
    v_add_u32 v252, s59, v252
    v_add_u32 v253, s59, v253
    ds_read_b128 v[224:227], v250 offset:0
    ds_read_b128 v[228:231], v251 offset:0
    ds_read_b128 v[232:235], v252 offset:0
    ds_read_b128 v[236:239], v253 offset:0
    v_subrev_u32 v250, s59, v250
    v_subrev_u32 v251, s59, v251
    v_subrev_u32 v252, s59, v252
    v_subrev_u32 v253, s59, v253
    s_waitcnt vmcnt(43)
    s_waitcnt lgkmcnt(3)
    v_mfma_f32_16x16x32_bf16 v[0:3], v[196:199], v[224:227], v[0:3]
    s_waitcnt lgkmcnt(2)
    v_mfma_f32_16x16x32_bf16 v[4:7], v[196:199], v[228:231], v[4:7]
    s_waitcnt lgkmcnt(1)
    v_mfma_f32_16x16x32_bf16 v[8:11], v[196:199], v[232:235], v[8:11]
    s_waitcnt lgkmcnt(0)
    v_mfma_f32_16x16x32_bf16 v[12:15], v[196:199], v[236:239], v[12:15]
    buffer_load_dwordx4 v[196:199], v244, s[20:23], s52 offen offset:3072 sc1
    s_waitcnt vmcnt(41)
    v_mfma_f32_16x16x32_bf16 v[16:19], v[200:203], v[224:227], v[16:19]
    v_mfma_f32_16x16x32_bf16 v[20:23], v[200:203], v[228:231], v[20:23]
    v_mfma_f32_16x16x32_bf16 v[24:27], v[200:203], v[232:235], v[24:27]
    v_mfma_f32_16x16x32_bf16 v[28:31], v[200:203], v[236:239], v[28:31]
    buffer_load_dwordx4 v[200:203], v244, s[20:23], s53 offen offset:3072 sc1
    s_waitcnt vmcnt(41)
    v_mfma_f32_16x16x32_bf16 v[32:35], v[204:207], v[224:227], v[32:35]
    v_mfma_f32_16x16x32_bf16 v[36:39], v[204:207], v[228:231], v[36:39]
    v_mfma_f32_16x16x32_bf16 v[40:43], v[204:207], v[232:235], v[40:43]
    v_mfma_f32_16x16x32_bf16 v[44:47], v[204:207], v[236:239], v[44:47]
    buffer_load_dwordx4 v[204:207], v244, s[20:23], s54 offen offset:3072 sc1
    s_waitcnt vmcnt(39)
    v_mfma_f32_16x16x32_bf16 v[48:51], v[208:211], v[224:227], v[48:51]
    v_mfma_f32_16x16x32_bf16 v[52:55], v[208:211], v[228:231], v[52:55]
    v_mfma_f32_16x16x32_bf16 v[56:59], v[208:211], v[232:235], v[56:59]
    v_mfma_f32_16x16x32_bf16 v[60:63], v[208:211], v[236:239], v[60:63]
    buffer_load_dwordx4 v[208:211], v244, s[20:23], s55 offen offset:3072 sc1
    s_waitcnt vmcnt(39)
    v_mfma_f32_16x16x32_bf16 v[64:67], v[212:215], v[224:227], v[64:67]
    v_mfma_f32_16x16x32_bf16 v[68:71], v[212:215], v[228:231], v[68:71]
    v_mfma_f32_16x16x32_bf16 v[72:75], v[212:215], v[232:235], v[72:75]
    v_mfma_f32_16x16x32_bf16 v[76:79], v[212:215], v[236:239], v[76:79]
    buffer_load_dwordx4 v[212:215], v244, s[20:23], s56 offen offset:3072 sc1
    s_waitcnt vmcnt(37)
    v_mfma_f32_16x16x32_bf16 v[80:83], v[216:219], v[224:227], v[80:83]
    v_mfma_f32_16x16x32_bf16 v[84:87], v[216:219], v[228:231], v[84:87]
    v_mfma_f32_16x16x32_bf16 v[88:91], v[216:219], v[232:235], v[88:91]
    v_mfma_f32_16x16x32_bf16 v[92:95], v[216:219], v[236:239], v[92:95]
    buffer_load_dwordx4 v[216:219], v244, s[20:23], s57 offen offset:3072 sc1
    s_waitcnt vmcnt(37)
    v_mfma_f32_16x16x32_bf16 v[96:99], v[220:223], v[224:227], v[96:99]
    v_mfma_f32_16x16x32_bf16 v[100:103], v[220:223], v[228:231], v[100:103]
    v_mfma_f32_16x16x32_bf16 v[104:107], v[220:223], v[232:235], v[104:107]
    v_mfma_f32_16x16x32_bf16 v[108:111], v[220:223], v[236:239], v[108:111]
    buffer_load_dwordx4 v[220:223], v244, s[20:23], s58 offen offset:3072 sc1
    s_waitcnt vmcnt(36)
    ds_read_b128 v[224:227], v246 offset:0
    ds_read_b128 v[228:231], v247 offset:0
    ds_read_b128 v[232:235], v248 offset:0
    ds_read_b128 v[236:239], v249 offset:0
    s_waitcnt vmcnt(35)
    s_waitcnt lgkmcnt(3)
    v_mfma_f32_16x16x32_bf16 v[0:3], v[112:115], v[224:227], v[0:3]
    s_waitcnt lgkmcnt(2)
    v_mfma_f32_16x16x32_bf16 v[4:7], v[112:115], v[228:231], v[4:7]
    s_waitcnt lgkmcnt(1)
    v_mfma_f32_16x16x32_bf16 v[8:11], v[112:115], v[232:235], v[8:11]
    s_waitcnt lgkmcnt(0)
    v_mfma_f32_16x16x32_bf16 v[12:15], v[112:115], v[236:239], v[12:15]
    s_waitcnt vmcnt(34)
    v_mfma_f32_16x16x32_bf16 v[16:19], v[116:119], v[224:227], v[16:19]
    v_mfma_f32_16x16x32_bf16 v[20:23], v[116:119], v[228:231], v[20:23]
    v_mfma_f32_16x16x32_bf16 v[24:27], v[116:119], v[232:235], v[24:27]
    v_mfma_f32_16x16x32_bf16 v[28:31], v[116:119], v[236:239], v[28:31]
    s_waitcnt vmcnt(33)
    v_mfma_f32_16x16x32_bf16 v[32:35], v[120:123], v[224:227], v[32:35]
    v_mfma_f32_16x16x32_bf16 v[36:39], v[120:123], v[228:231], v[36:39]
    v_mfma_f32_16x16x32_bf16 v[40:43], v[120:123], v[232:235], v[40:43]
    v_mfma_f32_16x16x32_bf16 v[44:47], v[120:123], v[236:239], v[44:47]
    s_waitcnt vmcnt(32)
    v_mfma_f32_16x16x32_bf16 v[48:51], v[124:127], v[224:227], v[48:51]
    v_mfma_f32_16x16x32_bf16 v[52:55], v[124:127], v[228:231], v[52:55]
    v_mfma_f32_16x16x32_bf16 v[56:59], v[124:127], v[232:235], v[56:59]
    v_mfma_f32_16x16x32_bf16 v[60:63], v[124:127], v[236:239], v[60:63]
    s_waitcnt vmcnt(31)
    v_mfma_f32_16x16x32_bf16 v[64:67], v[128:131], v[224:227], v[64:67]
    v_mfma_f32_16x16x32_bf16 v[68:71], v[128:131], v[228:231], v[68:71]
    v_mfma_f32_16x16x32_bf16 v[72:75], v[128:131], v[232:235], v[72:75]
    v_mfma_f32_16x16x32_bf16 v[76:79], v[128:131], v[236:239], v[76:79]
    s_waitcnt vmcnt(30)
    v_mfma_f32_16x16x32_bf16 v[80:83], v[132:135], v[224:227], v[80:83]
    v_mfma_f32_16x16x32_bf16 v[84:87], v[132:135], v[228:231], v[84:87]
    v_mfma_f32_16x16x32_bf16 v[88:91], v[132:135], v[232:235], v[88:91]
    v_mfma_f32_16x16x32_bf16 v[92:95], v[132:135], v[236:239], v[92:95]
    s_waitcnt vmcnt(29)
    v_mfma_f32_16x16x32_bf16 v[96:99], v[136:139], v[224:227], v[96:99]
    v_mfma_f32_16x16x32_bf16 v[100:103], v[136:139], v[228:231], v[100:103]
    v_mfma_f32_16x16x32_bf16 v[104:107], v[136:139], v[232:235], v[104:107]
    v_mfma_f32_16x16x32_bf16 v[108:111], v[136:139], v[236:239], v[108:111]
    s_lshl_b32 s43, s35, 2
    s_add_u32 s43, s43, s33
    s_mul_i32 s44, s43, 27648
    s_add_u32 s45, s37, 0
    s_lshr_b32 s46, s45, 1
    s_lshl_b32 s46, s46, 10
    s_and_b32 s45, s45, 1
    s_lshl_b32 s45, s45, 3
    s_add_u32 s45, s45, s46
    s_add_u32 s52, s45, s44
    s_add_u32 s45, s37, 1
    s_lshr_b32 s46, s45, 1
    s_lshl_b32 s46, s46, 10
    s_and_b32 s45, s45, 1
    s_lshl_b32 s45, s45, 3
    s_add_u32 s45, s45, s46
    s_add_u32 s53, s45, s44
    s_add_u32 s45, s37, 2
    s_lshr_b32 s46, s45, 1
    s_lshl_b32 s46, s46, 10
    s_and_b32 s45, s45, 1
    s_lshl_b32 s45, s45, 3
    s_add_u32 s45, s45, s46
    s_add_u32 s54, s45, s44
    s_add_u32 s45, s37, 3
    s_lshr_b32 s46, s45, 1
    s_lshl_b32 s46, s46, 10
    s_and_b32 s45, s45, 1
    s_lshl_b32 s45, s45, 3
    s_add_u32 s45, s45, s46
    s_add_u32 s55, s45, s44
    s_add_u32 s45, s37, 4
    s_lshr_b32 s46, s45, 1
    s_lshl_b32 s46, s46, 10
    s_and_b32 s45, s45, 1
    s_lshl_b32 s45, s45, 3
    s_add_u32 s45, s45, s46
    s_add_u32 s56, s45, s44
    s_add_u32 s45, s37, 5
    s_lshr_b32 s46, s45, 1
    s_lshl_b32 s46, s46, 10
    s_and_b32 s45, s45, 1
    s_lshl_b32 s45, s45, 3
    s_add_u32 s45, s45, s46
    s_add_u32 s57, s45, s44
    s_add_u32 s45, s37, 6
    s_lshr_b32 s46, s45, 1
    s_lshl_b32 s46, s46, 10
    s_and_b32 s45, s45, 1
    s_lshl_b32 s45, s45, 3
    s_add_u32 s45, s45, s46
    s_add_u32 s58, s45, s44
    s_cmp_eq_u32 s36, 3
    s_cselect_b32 s58, 1073741824, s58
    buffer_load_dwordx2 v[112:113], v244, s[24:27], s52 offen sc1
    buffer_load_dwordx2 v[114:115], v244, s[24:27], s53 offen sc1
    buffer_load_dwordx2 v[116:117], v244, s[24:27], s54 offen sc1
    buffer_load_dwordx2 v[118:119], v244, s[24:27], s55 offen sc1
    buffer_load_dwordx2 v[120:121], v244, s[24:27], s56 offen sc1
    buffer_load_dwordx2 v[122:123], v244, s[24:27], s57 offen sc1
    buffer_load_dwordx2 v[124:125], v244, s[24:27], s58 offen sc1
    s_lshr_b32 s44, s43, 1
    s_lshl_b32 s44, s44, 5
    s_and_b32 s45, s43, 1
    s_lshl_b32 s45, s45, 2
    s_add_u32 s44, s44, s45
    v_lshrrev_b32 v128, 2, v240
    v_and_b32 v129, 3, v240
    v_lshl_add_u32 v128, v128, 3, v129
    v_add_u32 v128, s44, v128
    v_lshlrev_b32 v128, 1, v128
    buffer_load_ushort v126, v128, s[64:67], 0 offen
    v_mov_b32 v255, 2
    ds_write_b32 v254, v255
    ds_read_b128 v[224:227], v250 offset:0
    ds_read_b128 v[228:231], v251 offset:0
    ds_read_b128 v[232:235], v252 offset:0
    ds_read_b128 v[236:239], v253 offset:0
    s_waitcnt vmcnt(36)
    s_waitcnt lgkmcnt(3)
    v_mfma_f32_16x16x32_bf16 v[0:3], v[140:143], v[224:227], v[0:3]
    s_waitcnt lgkmcnt(2)
    v_mfma_f32_16x16x32_bf16 v[4:7], v[140:143], v[228:231], v[4:7]
    s_waitcnt lgkmcnt(1)
    v_mfma_f32_16x16x32_bf16 v[8:11], v[140:143], v[232:235], v[8:11]
    s_waitcnt lgkmcnt(0)
    v_mfma_f32_16x16x32_bf16 v[12:15], v[140:143], v[236:239], v[12:15]
    s_waitcnt vmcnt(33)
    v_mfma_f32_16x16x32_bf16 v[16:19], v[144:147], v[224:227], v[16:19]
    v_mfma_f32_16x16x32_bf16 v[20:23], v[144:147], v[228:231], v[20:23]
    v_mfma_f32_16x16x32_bf16 v[24:27], v[144:147], v[232:235], v[24:27]
    v_mfma_f32_16x16x32_bf16 v[28:31], v[144:147], v[236:239], v[28:31]
    s_waitcnt vmcnt(32)
    v_mfma_f32_16x16x32_bf16 v[32:35], v[148:151], v[224:227], v[32:35]
    v_mfma_f32_16x16x32_bf16 v[36:39], v[148:151], v[228:231], v[36:39]
    v_mfma_f32_16x16x32_bf16 v[40:43], v[148:151], v[232:235], v[40:43]
    v_mfma_f32_16x16x32_bf16 v[44:47], v[148:151], v[236:239], v[44:47]
    s_waitcnt vmcnt(29)
    v_mfma_f32_16x16x32_bf16 v[48:51], v[152:155], v[224:227], v[48:51]
    v_mfma_f32_16x16x32_bf16 v[52:55], v[152:155], v[228:231], v[52:55]
    v_mfma_f32_16x16x32_bf16 v[56:59], v[152:155], v[232:235], v[56:59]
    v_mfma_f32_16x16x32_bf16 v[60:63], v[152:155], v[236:239], v[60:63]
    s_waitcnt vmcnt(28)
    v_mfma_f32_16x16x32_bf16 v[64:67], v[156:159], v[224:227], v[64:67]
    v_mfma_f32_16x16x32_bf16 v[68:71], v[156:159], v[228:231], v[68:71]
    v_mfma_f32_16x16x32_bf16 v[72:75], v[156:159], v[232:235], v[72:75]
    v_mfma_f32_16x16x32_bf16 v[76:79], v[156:159], v[236:239], v[76:79]
    s_waitcnt vmcnt(25)
    v_mfma_f32_16x16x32_bf16 v[80:83], v[160:163], v[224:227], v[80:83]
    v_mfma_f32_16x16x32_bf16 v[84:87], v[160:163], v[228:231], v[84:87]
    v_mfma_f32_16x16x32_bf16 v[88:91], v[160:163], v[232:235], v[88:91]
    v_mfma_f32_16x16x32_bf16 v[92:95], v[160:163], v[236:239], v[92:95]
    s_waitcnt vmcnt(24)
    v_mfma_f32_16x16x32_bf16 v[96:99], v[164:167], v[224:227], v[96:99]
    v_mfma_f32_16x16x32_bf16 v[100:103], v[164:167], v[228:231], v[100:103]
    v_mfma_f32_16x16x32_bf16 v[104:107], v[164:167], v[232:235], v[104:107]
    v_mfma_f32_16x16x32_bf16 v[108:111], v[164:167], v[236:239], v[108:111]
    s_waitcnt vmcnt(22)
    ds_read_b128 v[224:227], v246 offset:8192
    ds_read_b128 v[228:231], v247 offset:8192
    ds_read_b128 v[232:235], v248 offset:8192
    ds_read_b128 v[236:239], v249 offset:8192
    s_waitcnt vmcnt(21)
    s_waitcnt lgkmcnt(3)
    v_mfma_f32_16x16x32_bf16 v[0:3], v[168:171], v[224:227], v[0:3]
    s_waitcnt lgkmcnt(2)
    v_mfma_f32_16x16x32_bf16 v[4:7], v[168:171], v[228:231], v[4:7]
    s_waitcnt lgkmcnt(1)
    v_mfma_f32_16x16x32_bf16 v[8:11], v[168:171], v[232:235], v[8:11]
    s_waitcnt lgkmcnt(0)
    v_mfma_f32_16x16x32_bf16 v[12:15], v[168:171], v[236:239], v[12:15]
    s_waitcnt vmcnt(20)
    v_mfma_f32_16x16x32_bf16 v[16:19], v[172:175], v[224:227], v[16:19]
    v_mfma_f32_16x16x32_bf16 v[20:23], v[172:175], v[228:231], v[20:23]
    v_mfma_f32_16x16x32_bf16 v[24:27], v[172:175], v[232:235], v[24:27]
    v_mfma_f32_16x16x32_bf16 v[28:31], v[172:175], v[236:239], v[28:31]
    s_waitcnt vmcnt(19)
    v_mfma_f32_16x16x32_bf16 v[32:35], v[176:179], v[224:227], v[32:35]
    v_mfma_f32_16x16x32_bf16 v[36:39], v[176:179], v[228:231], v[36:39]
    v_mfma_f32_16x16x32_bf16 v[40:43], v[176:179], v[232:235], v[40:43]
    v_mfma_f32_16x16x32_bf16 v[44:47], v[176:179], v[236:239], v[44:47]
    s_waitcnt vmcnt(18)
    v_mfma_f32_16x16x32_bf16 v[48:51], v[180:183], v[224:227], v[48:51]
    v_mfma_f32_16x16x32_bf16 v[52:55], v[180:183], v[228:231], v[52:55]
    v_mfma_f32_16x16x32_bf16 v[56:59], v[180:183], v[232:235], v[56:59]
    v_mfma_f32_16x16x32_bf16 v[60:63], v[180:183], v[236:239], v[60:63]
    s_waitcnt vmcnt(17)
    v_mfma_f32_16x16x32_bf16 v[64:67], v[184:187], v[224:227], v[64:67]
    v_mfma_f32_16x16x32_bf16 v[68:71], v[184:187], v[228:231], v[68:71]
    v_mfma_f32_16x16x32_bf16 v[72:75], v[184:187], v[232:235], v[72:75]
    v_mfma_f32_16x16x32_bf16 v[76:79], v[184:187], v[236:239], v[76:79]
    s_waitcnt vmcnt(16)
    v_mfma_f32_16x16x32_bf16 v[80:83], v[188:191], v[224:227], v[80:83]
    v_mfma_f32_16x16x32_bf16 v[84:87], v[188:191], v[228:231], v[84:87]
    v_mfma_f32_16x16x32_bf16 v[88:91], v[188:191], v[232:235], v[88:91]
    v_mfma_f32_16x16x32_bf16 v[92:95], v[188:191], v[236:239], v[92:95]
    s_waitcnt vmcnt(15)
    v_mfma_f32_16x16x32_bf16 v[96:99], v[192:195], v[224:227], v[96:99]
    v_mfma_f32_16x16x32_bf16 v[100:103], v[192:195], v[228:231], v[100:103]
    v_mfma_f32_16x16x32_bf16 v[104:107], v[192:195], v[232:235], v[104:107]
    v_mfma_f32_16x16x32_bf16 v[108:111], v[192:195], v[236:239], v[108:111]
    ds_read_b128 v[224:227], v250 offset:8192
    ds_read_b128 v[228:231], v251 offset:8192
    ds_read_b128 v[232:235], v252 offset:8192
    ds_read_b128 v[236:239], v253 offset:8192
    v_add_u32 v130, s39, v244
    v_add_u32 v131, s38, v244
    v_add_u32 v133, 16, v254
    s_waitcnt vmcnt(8)
    s_waitcnt lgkmcnt(0)
    v_mfma_f32_16x16x32_bf16 v[4:7], v[196:199], v[228:231], v[4:7]
    v_mfma_f32_16x16x32_bf16 v[20:23], v[200:203], v[228:231], v[20:23]
    v_mfma_f32_16x16x32_bf16 v[36:39], v[204:207], v[228:231], v[36:39]
    v_mfma_f32_16x16x32_bf16 v[52:55], v[208:211], v[228:231], v[52:55]
    v_mfma_f32_16x16x32_bf16 v[68:71], v[212:215], v[228:231], v[68:71]
    v_mfma_f32_16x16x32_bf16 v[84:87], v[216:219], v[228:231], v[84:87]
    v_mfma_f32_16x16x32_bf16 v[100:103], v[220:223], v[228:231], v[100:103]
    v_mfma_f32_16x16x32_bf16 v[8:11], v[196:199], v[232:235], v[8:11]
    v_mfma_f32_16x16x32_bf16 v[24:27], v[200:203], v[232:235], v[24:27]
    v_mfma_f32_16x16x32_bf16 v[40:43], v[204:207], v[232:235], v[40:43]
    ds_write_b128 v130, v[4:7] offset:0
    v_mfma_f32_16x16x32_bf16 v[56:59], v[208:211], v[232:235], v[56:59]
    ds_write_b128 v130, v[20:23] offset:1024
    v_mfma_f32_16x16x32_bf16 v[72:75], v[212:215], v[232:235], v[72:75]
    ds_write_b128 v130, v[36:39] offset:2048
    v_mfma_f32_16x16x32_bf16 v[88:91], v[216:219], v[232:235], v[88:91]
    ds_write_b128 v130, v[52:55] offset:3072
    v_mfma_f32_16x16x32_bf16 v[104:107], v[220:223], v[232:235], v[104:107]
    ds_write_b128 v130, v[68:71] offset:4096
    v_mfma_f32_16x16x32_bf16 v[12:15], v[196:199], v[236:239], v[12:15]
    ds_write_b128 v130, v[84:87] offset:5120
    v_mfma_f32_16x16x32_bf16 v[28:31], v[200:203], v[236:239], v[28:31]
    ds_write_b128 v130, v[100:103] offset:6144
    v_mfma_f32_16x16x32_bf16 v[44:47], v[204:207], v[236:239], v[44:47]
    ds_write_b128 v130, v[8:11] offset:7168
    v_mfma_f32_16x16x32_bf16 v[60:63], v[208:211], v[236:239], v[60:63]
    ds_write_b128 v130, v[24:27] offset:8192
    v_mfma_f32_16x16x32_bf16 v[76:79], v[212:215], v[236:239], v[76:79]
    ds_write_b128 v130, v[40:43] offset:9216
    v_mfma_f32_16x16x32_bf16 v[92:95], v[216:219], v[236:239], v[92:95]
    ds_write_b128 v130, v[56:59] offset:10240
    v_mfma_f32_16x16x32_bf16 v[108:111], v[220:223], v[236:239], v[108:111]
    ds_write_b128 v130, v[72:75] offset:11264
    v_mfma_f32_16x16x32_bf16 v[0:3], v[196:199], v[224:227], v[0:3]
    ds_write_b128 v130, v[88:91] offset:12288
    v_mfma_f32_16x16x32_bf16 v[16:19], v[200:203], v[224:227], v[16:19]
    ds_write_b128 v130, v[104:107] offset:13312
    v_mfma_f32_16x16x32_bf16 v[32:35], v[204:207], v[224:227], v[32:35]
    ds_write_b128 v131, v[12:15] offset:0
    v_mfma_f32_16x16x32_bf16 v[48:51], v[208:211], v[224:227], v[48:51]
    ds_write_b128 v131, v[28:31] offset:1024
    v_mfma_f32_16x16x32_bf16 v[64:67], v[212:215], v[224:227], v[64:67]
    ds_write_b128 v131, v[44:47] offset:2048
    v_mfma_f32_16x16x32_bf16 v[80:83], v[216:219], v[224:227], v[80:83]
    ds_write_b128 v131, v[60:63] offset:3072
    v_mfma_f32_16x16x32_bf16 v[96:99], v[220:223], v[224:227], v[96:99]
    ds_write_b128 v131, v[76:79] offset:4096
    ds_write_b128 v131, v[92:95] offset:5120
    ds_write_b128 v131, v[108:111] offset:6144
    ds_write_b32 v133, v255
    s_xor_b32 s43, s33, 1
    s_mul_i32 s43, s43, 16384
    v_add_u32 v130, s43, v244
    s_xor_b32 s43, s33, 2
    s_mul_i32 s43, s43, 16384
    v_add_u32 v131, s43, v244
    s_xor_b32 s43, s33, 3
    s_lshl_b32 s43, s43, 13
    s_add_u32 s43, s43, 111616
    v_add_u32 v132, s43, v244
    v_mov_b32 v134, 163744
    s_waitcnt vmcnt(0)
    v_lshlrev_b32 v126, 16, v126
    s_waitcnt lgkmcnt(0)
    v_lshlrev_b32 v4, 16, v112
    v_and_b32 v5, 0xffff0000, v112
    v_lshlrev_b32 v6, 16, v113
    v_and_b32 v7, 0xffff0000, v113
    v_lshlrev_b32 v20, 16, v114
    v_and_b32 v21, 0xffff0000, v114
    v_lshlrev_b32 v22, 16, v115
    v_and_b32 v23, 0xffff0000, v115
    v_lshlrev_b32 v36, 16, v116
    v_and_b32 v37, 0xffff0000, v116
    v_lshlrev_b32 v38, 16, v117
    v_and_b32 v39, 0xffff0000, v117
    v_lshlrev_b32 v52, 16, v118
    v_and_b32 v53, 0xffff0000, v118
    v_lshlrev_b32 v54, 16, v119
    v_and_b32 v55, 0xffff0000, v119
    v_lshlrev_b32 v68, 16, v120
    v_and_b32 v69, 0xffff0000, v120
    v_lshlrev_b32 v70, 16, v121
    v_and_b32 v71, 0xffff0000, v121
    v_lshlrev_b32 v84, 16, v122
    v_and_b32 v85, 0xffff0000, v122
    v_lshlrev_b32 v86, 16, v123
    v_and_b32 v87, 0xffff0000, v123
    v_lshlrev_b32 v100, 16, v124
    v_and_b32 v101, 0xffff0000, v124
    v_lshlrev_b32 v102, 16, v125
    v_and_b32 v103, 0xffff0000, v125
    v_pk_add_f32 v[0:1], v[0:1], v[126:127] op_sel_hi:[1,0]
    v_pk_add_f32 v[2:3], v[2:3], v[126:127] op_sel_hi:[1,0]
    v_pk_add_f32 v[16:17], v[16:17], v[126:127] op_sel_hi:[1,0]
    v_pk_add_f32 v[18:19], v[18:19], v[126:127] op_sel_hi:[1,0]
    v_pk_add_f32 v[32:33], v[32:33], v[126:127] op_sel_hi:[1,0]
    v_pk_add_f32 v[34:35], v[34:35], v[126:127] op_sel_hi:[1,0]
    v_pk_add_f32 v[48:49], v[48:49], v[126:127] op_sel_hi:[1,0]
    v_pk_add_f32 v[50:51], v[50:51], v[126:127] op_sel_hi:[1,0]
    v_pk_add_f32 v[64:65], v[64:65], v[126:127] op_sel_hi:[1,0]
    v_pk_add_f32 v[66:67], v[66:67], v[126:127] op_sel_hi:[1,0]
    v_pk_add_f32 v[80:81], v[80:81], v[126:127] op_sel_hi:[1,0]
    v_pk_add_f32 v[82:83], v[82:83], v[126:127] op_sel_hi:[1,0]
    v_pk_add_f32 v[96:97], v[96:97], v[126:127] op_sel_hi:[1,0]
    v_pk_add_f32 v[98:99], v[98:99], v[126:127] op_sel_hi:[1,0]
    s_mov_b32 s75, 0
m_wr1:
    ds_read_b128 v[136:139], v134
    s_add_u32 s75, s75, 1
    s_waitcnt lgkmcnt(0)
    s_cmp_ge_u32 s75, 2097152
    s_cbranch_scc1 m_wr1_ok
m_wr1_chk:
    v_min_u32 v136, v136, v138
    v_min_u32 v137, v137, v139
    v_min_u32 v136, v136, v137
    s_nop 0
    v_readfirstlane_b32 s43, v136
    s_cmp_lt_u32 s43, 1
    s_cbranch_scc1 m_wr1
m_wr1_ok:
    ds_read_b128 v[140:143], v130 offset:0
    ds_read_b128 v[144:147], v130 offset:1024
    ds_read_b128 v[148:151], v130 offset:2048
    ds_read_b128 v[152:155], v130 offset:3072
    ds_read_b128 v[156:159], v130 offset:4096
    ds_read_b128 v[160:163], v130 offset:5120
    ds_read_b128 v[164:167], v130 offset:6144
    ds_read_b128 v[168:171], v131 offset:7168
    ds_read_b128 v[172:175], v131 offset:8192
    ds_read_b128 v[176:179], v131 offset:9216
    ds_read_b128 v[180:183], v131 offset:10240
    ds_read_b128 v[184:187], v131 offset:11264
    ds_read_b128 v[188:191], v131 offset:12288
    ds_read_b128 v[192:195], v131 offset:13312
    ds_read_b128 v[196:199], v132 offset:0
    ds_read_b128 v[200:203], v132 offset:1024
    ds_read_b128 v[204:207], v132 offset:2048
    ds_read_b128 v[208:211], v132 offset:3072
    ds_read_b128 v[212:215], v132 offset:4096
    ds_read_b128 v[216:219], v132 offset:5120
    ds_read_b128 v[220:223], v132 offset:6144
    s_waitcnt lgkmcnt(14)
    v_pk_add_f32 v[0:1], v[0:1], v[140:141]
    v_pk_add_f32 v[2:3], v[2:3], v[142:143]
    v_pk_add_f32 v[16:17], v[16:17], v[144:145]
    v_pk_add_f32 v[18:19], v[18:19], v[146:147]
    v_pk_add_f32 v[32:33], v[32:33], v[148:149]
    v_pk_add_f32 v[34:35], v[34:35], v[150:151]
    v_pk_add_f32 v[48:49], v[48:49], v[152:153]
    v_pk_add_f32 v[50:51], v[50:51], v[154:155]
    v_pk_add_f32 v[64:65], v[64:65], v[156:157]
    v_pk_add_f32 v[66:67], v[66:67], v[158:159]
    v_pk_add_f32 v[80:81], v[80:81], v[160:161]
    v_pk_add_f32 v[82:83], v[82:83], v[162:163]
    v_pk_add_f32 v[96:97], v[96:97], v[164:165]
    v_pk_add_f32 v[98:99], v[98:99], v[166:167]
    s_waitcnt lgkmcnt(7)
    v_pk_add_f32 v[0:1], v[0:1], v[168:169]
    v_pk_add_f32 v[2:3], v[2:3], v[170:171]
    v_pk_add_f32 v[16:17], v[16:17], v[172:173]
    v_pk_add_f32 v[18:19], v[18:19], v[174:175]
    v_pk_add_f32 v[32:33], v[32:33], v[176:177]
    v_pk_add_f32 v[34:35], v[34:35], v[178:179]
    v_pk_add_f32 v[48:49], v[48:49], v[180:181]
    v_pk_add_f32 v[50:51], v[50:51], v[182:183]
    v_pk_add_f32 v[64:65], v[64:65], v[184:185]
    v_pk_add_f32 v[66:67], v[66:67], v[186:187]
    v_pk_add_f32 v[80:81], v[80:81], v[188:189]
    v_pk_add_f32 v[82:83], v[82:83], v[190:191]
    v_pk_add_f32 v[96:97], v[96:97], v[192:193]
    v_pk_add_f32 v[98:99], v[98:99], v[194:195]
    s_waitcnt lgkmcnt(0)
    ds_write_b32 v133, v255 offset:16
    v_pk_add_f32 v[0:1], v[0:1], v[196:197]
    v_pk_add_f32 v[2:3], v[2:3], v[198:199]
    v_pk_add_f32 v[16:17], v[16:17], v[200:201]
    v_pk_add_f32 v[18:19], v[18:19], v[202:203]
    v_pk_add_f32 v[32:33], v[32:33], v[204:205]
    v_pk_add_f32 v[34:35], v[34:35], v[206:207]
    v_pk_add_f32 v[48:49], v[48:49], v[208:209]
    v_pk_add_f32 v[50:51], v[50:51], v[210:211]
    v_pk_add_f32 v[64:65], v[64:65], v[212:213]
    v_pk_add_f32 v[66:67], v[66:67], v[214:215]
    v_pk_add_f32 v[80:81], v[80:81], v[216:217]
    v_pk_add_f32 v[82:83], v[82:83], v[218:219]
    v_pk_add_f32 v[96:97], v[96:97], v[220:221]
    v_pk_add_f32 v[98:99], v[98:99], v[222:223]
    v_pk_mul_f32 v[0:1], v[0:1], v[4:5]
    v_pk_mul_f32 v[2:3], v[2:3], v[6:7]
    v_pk_mul_f32 v[16:17], v[16:17], v[20:21]
    v_pk_mul_f32 v[18:19], v[18:19], v[22:23]
    v_pk_mul_f32 v[32:33], v[32:33], v[36:37]
    v_pk_mul_f32 v[34:35], v[34:35], v[38:39]
    v_pk_mul_f32 v[48:49], v[48:49], v[52:53]
    v_pk_mul_f32 v[50:51], v[50:51], v[54:55]
    v_pk_mul_f32 v[64:65], v[64:65], v[68:69]
    v_pk_mul_f32 v[66:67], v[66:67], v[70:71]
    v_pk_mul_f32 v[80:81], v[80:81], v[84:85]
    v_pk_mul_f32 v[82:83], v[82:83], v[86:87]
    v_pk_mul_f32 v[96:97], v[96:97], v[100:101]
    v_pk_mul_f32 v[98:99], v[98:99], v[102:103]
    v_cvt_pk_bf16_f32 v200, v0, v1
    v_cvt_pk_bf16_f32 v201, v2, v3
    v_cvt_pk_bf16_f32 v202, v16, v17
    v_cvt_pk_bf16_f32 v203, v18, v19
    v_cvt_pk_bf16_f32 v204, v32, v33
    v_cvt_pk_bf16_f32 v205, v34, v35
    v_cvt_pk_bf16_f32 v206, v48, v49
    v_cvt_pk_bf16_f32 v207, v50, v51
    v_cvt_pk_bf16_f32 v208, v64, v65
    v_cvt_pk_bf16_f32 v209, v66, v67
    v_cvt_pk_bf16_f32 v210, v80, v81
    v_cvt_pk_bf16_f32 v211, v82, v83
    v_cvt_pk_bf16_f32 v212, v96, v97
    v_cvt_pk_bf16_f32 v213, v98, v99
    s_bitcmp1_b32 s37, 0
    s_cbranch_scc1 m_hodd
    buffer_store_dwordx4 v[200:203], v244, s[28:31], s52 offen sc1
    buffer_store_dwordx4 v[204:207], v244, s[28:31], s54 offen sc1
    buffer_store_dwordx4 v[208:211], v244, s[28:31], s56 offen sc1
    buffer_store_dwordx2 v[212:213], v244, s[28:31], s58 offen sc1
    s_branch m_hdone
m_hodd:
    buffer_store_dwordx2 v[200:201], v244, s[28:31], s52 offen sc1
    buffer_store_dwordx4 v[202:205], v244, s[28:31], s53 offen sc1
    buffer_store_dwordx4 v[206:209], v244, s[28:31], s55 offen sc1
    s_cmp_eq_u32 s36, 3
    s_cbranch_scc1 m_hodd6
    buffer_store_dwordx4 v[210:213], v244, s[28:31], s57 offen sc1
    s_branch m_hdone
m_hodd6:
    buffer_store_dwordx2 v[210:211], v244, s[28:31], s57 offen sc1
m_hdone:
    v_mov_b32 v1, v245
    s_and_b32 s43, s41, 1
    s_lshl_b32 s43, s43, 2
    s_add_u32 s36, s36, s43
    v_mov_b32 v4, 163720
    v_mov_b32 v5, 1
    v_lshlrev_b32 v6, 7, v1
    v_mov_b32 v7, s3
    s_lshl_b32 s44, s35, 10
    s_lshl_b32 s45, s36, 2
    s_add_u32 s44, s44, s45
    s_add_u32 s44, s44, 16384
    s_mov_b64 exec, 1
    s_waitcnt vmcnt(0)
    ds_add_rtn_u32 v8, v4, v5
    s_waitcnt lgkmcnt(0)
    v_readfirstlane_b32 s43, v8
    s_mov_b64 exec, 0xff
    s_cmp_lg_u32 s43, 3
    s_cbranch_scc1 m_nopub
    buffer_store_dword v7, v6, s[60:63], s44 offen sc1
m_nopub:
    s_mov_b64 exec, -1
    s_setprio 0
    v_and_b32 v2, 15, v1
    v_lshrrev_b32 v3, 4, v1
    s_mov_b32 s47, 0
    s_mov_b32 s46, 0
m_P3:
    s_lshr_b32 s34, s32, 2
    v_lshlrev_b32 v15, 4, v1
    s_add_u32 s16, s14, 23068672
    s_addc_u32 s17, s15, 0
    s_mov_b32 s18, 1105920
    s_mov_b32 s19, 0x00020000
    s_add_u32 s20, s14, 12582912
    s_addc_u32 s21, s15, 0
    s_mov_b32 s22, 3538944
    s_mov_b32 s23, 0x00020000
    s_mov_b32 s24, s4
    s_mov_b32 s25, s5
    s_mov_b32 s26, 2621440
    s_mov_b32 s27, 0x00020000
    s_mov_b32 s28, s98
    s_mov_b32 s29, s99
    s_mov_b32 s30, 2621440
    s_mov_b32 s31, 0x00020000
    s_cmp_eq_u32 s33, 3
    s_cselect_b32 s45, 1073741824, 6144
    s_and_b32 s43, s33, 1
    s_lshl_b32 s44, s34, 1
    s_add_u32 s57, s43, s44
    s_lshr_b32 s58, s33, 1
    s_mul_i32 s58, s58, 3
    s_lshr_b32 s43, s57, 1
    s_lshl_b32 s43, s43, 5
    s_and_b32 s44, s57, 1
    s_lshl_b32 s44, s44, 2
    s_add_u32 s59, s43, s44
    s_lshl_b32 s43, s35, 6
    s_add_u32 s43, s43, s59
    v_lshrrev_b32 v6, 2, v2
    v_and_b32 v7, 3, v2
    v_lshl_add_u32 v6, v6, 3, v7
    v_add_u32 v6, s43, v6
    v_mul_u32_u24 v6, 1280, v6
    v_lshl_add_u32 v6, v3, 3, v6
    s_mul_i32 s43, s36, 160
    v_add_u32 v14, s43, v6
    s_add_u32 s43, s58, 0
    s_min_u32 s68, s43, 4
    s_lshl_b32 s72, s68, 5
    s_add_u32 s43, s58, 1
    s_min_u32 s69, s43, 4
    s_lshl_b32 s73, s69, 5
    s_add_u32 s43, s58, 2
    s_min_u32 s70, s43, 4
    s_lshl_b32 s74, s70, 5
    s_add_u32 s64, s14, 16777216
    s_addc_u32 s65, s15, 0
    s_mov_b32 s66, 2621440
    s_mov_b32 s67, 0x00020000
    s_lshl_b32 s43, s35, 2
    s_lshl_b32 s44, s34, 1
    s_add_u32 s43, s43, s44
    s_mul_i32 s43, s43, 27
    s_mul_i32 s44, s33, 7
    s_add_u32 s43, s43, s44
    s_lshl_b32 s46, s43, 10
    s_add_u32 s47, s46, 27648
    s_add_u32 s48, s46, 4096
    s_add_u32 s49, s47, 4096
    s_add_u32 s50, s46, s45
    s_add_u32 s51, s47, s45
    s_mul_i32 s43, s33, 35840
    s_add_u32 s43, s43, 22528
    v_add_u32 v252, s43, v15
    s_cmp_eq_u32 s33, 3
    s_cselect_b32 s43, 5120, 0
    v_subrev_u32 v253, s43, v252
    v_and_b32 v4, 7, v1
    v_lshlrev_b32 v4, 2, v4
    s_lshl_b32 s44, s35, 10
    s_lshl_b32 s43, s36, 7
    s_add_u32 s44, s44, s43
    s_add_u32 s44, s44, 16384
    v_min_u32 v254, 39, v1
    v_lshlrev_b32 v254, 3, v254
    s_mul_i32 s52, s36, 320
    s_add_u32 s52, s52, 6144
    s_cmp_ge_u32 s32, 4
    s_cbranch_scc1 m_nwv
    s_waitcnt vmcnt(0)
m_nwv:
    s_barrier
    s_cmp_lg_u32 s32, 3
    s_cbranch_scc1 m_nhp
    buffer_load_dword v5, v4, s[60:63], s44 offen sc1
m_nhp:
    s_cmp_lg_u32 s32, 2
    s_cbranch_scc1 m_nyp
    buffer_load_dwordx2 v[248:249], v254, s[60:63], s52 offen sc1
m_nyp:
    ds_read_b128 v[72:75], v252 offset:0
    ds_read_b128 v[76:79], v252 offset:1024
    ds_read_b128 v[80:83], v252 offset:2048
    ds_read_b128 v[84:87], v252 offset:3072
    ds_read_b128 v[88:91], v252 offset:4096
    ds_read_b128 v[92:95], v252 offset:5120
    ds_read_b128 v[96:99], v252 offset:6144
    ds_read_b128 v[100:103], v252 offset:7168
    ds_read_b128 v[104:107], v252 offset:8192
    ds_read_b128 v[108:111], v252 offset:9216
    ds_read_b128 v[112:115], v252 offset:10240
    ds_read_b128 v[116:119], v252 offset:11264
    ds_read_b128 v[120:123], v252 offset:12288
    ds_read_b128 v[124:127], v252 offset:13312
    ds_read_b128 v[128:131], v252 offset:14336
    ds_read_b128 v[132:135], v252 offset:15360
    ds_read_b128 v[136:139], v252 offset:16384
    ds_read_b128 v[140:143], v252 offset:17408
    ds_read_b128 v[144:147], v252 offset:18432
    ds_read_b128 v[148:151], v252 offset:19456
    ds_read_b128 v[152:155], v252 offset:20480
    ds_read_b128 v[156:159], v252 offset:21504
    ds_read_b128 v[160:163], v252 offset:22528
    ds_read_b128 v[164:167], v252 offset:23552
    ds_read_b128 v[168:171], v252 offset:24576
    ds_read_b128 v[172:175], v252 offset:25600
    ds_read_b128 v[176:179], v252 offset:26624
    ds_read_b128 v[180:183], v252 offset:27648
    ds_read_b128 v[184:187], v252 offset:28672
    ds_read_b128 v[188:191], v252 offset:29696
    ds_read_b128 v[192:195], v253 offset:30720
    ds_read_b128 v[196:199], v253 offset:31744
    ds_read_b128 v[200:203], v253 offset:32768
    ds_read_b128 v[204:207], v253 offset:33792
    ds_read_b128 v[208:211], v253 offset:34816
    buffer_load_dwordx2 v[8:9], v14, s[24:27], s72 offen
    buffer_load_dwordx2 v[10:11], v14, s[24:27], s73 offen
    buffer_load_dwordx2 v[12:13], v14, s[24:27], s74 offen
    v_lshrrev_b32 v244, 3, v1
    v_lshlrev_b32 v244, 12, v244
    v_and_b32 v245, 7, v1
    v_lshl_add_u32 v244, v245, 4, v244
    s_mul_i32 s53, s36, 80
    s_lshl_b32 s43, s32, 3
    s_add_u32 s53, s53, s43
    s_lshl_b32 s53, s53, 12
    s_lshl_b32 s43, s35, 7
    s_add_u32 s53, s53, s43
    s_cmp_lt_u32 s32, 2
    s_cselect_b32 s54, 262144, 0
    s_cselect_b32 s55, 8192, 0
    s_add_u32 s54, s54, s53
    s_lshl_b32 s43, s32, 10
    s_add_u32 s43, s43, 81920
    v_add_u32 v246, s43, v15
    v_add_u32 v247, s55, v246
    s_cmp_lg_u32 s32, 3
    s_cbranch_scc1 m_hw
    s_mov_b32 s40, 0
    s_branch m_pollh_pre
m_pollh:
    s_sleep 2
m_pollh_1st:
    buffer_load_dword v5, v4, s[60:63], s44 offen offset:0 sc1
    s_add_u32 s40, s40, 1
m_pollh_pre:
    s_waitcnt vmcnt(0)
    v_xor_b32 v6, s3, v5
    v_cmp_ne_u32 vcc, 0, v6
    s_cmp_ge_u32 s40, 262144
    s_cbranch_scc1 m_pollh_ok
    s_cbranch_vccnz m_pollh
m_pollh_ok:
m_hw:
    s_cmp_lg_u32 s32, 2
    s_cbranch_scc1 m_noy
    s_mov_b32 s40, 0
    s_branch m_polly_pre
m_polly:
    s_sleep 8
m_polly_1st:
    buffer_load_dwordx2 v[248:249], v254, s[60:63], s52 offen offset:0 sc1
    s_add_u32 s40, s40, 1
m_polly_pre:
    s_waitcnt vmcnt(0)
    v_xor_b32 v5, s3, v248
    v_xor_b32 v249, s3, v249
    v_or_b32 v5, v5, v249
    v_cmp_ne_u32 vcc, 0, v5
    s_cmp_ge_u32 s40, 262144
    s_cbranch_scc1 m_polly_ok
    s_cbranch_vccnz m_polly
m_polly_ok:
m_noy:
    s_waitcnt lgkmcnt(0)
    s_barrier
    buffer_load_dwordx4 v[236:239], v244, s[64:67], s53 offen sc1
    buffer_load_dwordx4 v[240:243], v244, s[64:67], s54 offen sc1
    buffer_load_dwordx4 v[16:19], v15, s[20:23], s46 offen offset:0 sc1
    buffer_load_dwordx4 v[20:23], v15, s[20:23], s47 offen offset:0 sc1
    buffer_load_dwordx4 v[24:27], v15, s[20:23], s46 offen offset:1024 sc1
    buffer_load_dwordx4 v[28:31], v15, s[20:23], s47 offen offset:1024 sc1
    buffer_load_dwordx4 v[32:35], v15, s[20:23], s46 offen offset:2048 sc1
    buffer_load_dwordx4 v[36:39], v15, s[20:23], s47 offen offset:2048 sc1
    buffer_load_dwordx4 v[40:43], v15, s[20:23], s46 offen offset:3072 sc1
    buffer_load_dwordx4 v[44:47], v15, s[20:23], s47 offen offset:3072 sc1
    buffer_load_dwordx4 v[48:51], v15, s[20:23], s48 offen offset:0 sc1
    buffer_load_dwordx4 v[52:55], v15, s[20:23], s49 offen offset:0 sc1
    buffer_load_dwordx4 v[56:59], v15, s[20:23], s48 offen offset:1024 sc1
    buffer_load_dwordx4 v[60:63], v15, s[20:23], s49 offen offset:1024 sc1
    buffer_load_dwordx4 v[64:67], v15, s[20:23], s50 offen offset:0 sc1
    buffer_load_dwordx4 v[68:71], v15, s[20:23], s51 offen offset:0 sc1
    s_mul_i32 s43, s32, 10240
    v_add_u32 v252, s43, v15
    s_mul_i32 s43, s34, 40960
    s_and_b32 s44, s33, 1
    s_mul_i32 s44, s44, 5120
    s_add_u32 s43, s43, s44
    v_bfe_u32 v4, v1, 2, 2
    v_lshl_add_u32 v4, v3, 2, v4
    v_lshlrev_b32 v4, 7, v4
    v_and_b32 v5, 3, v1
    v_lshl_add_u32 v4, v5, 4, v4
    s_lshl_b32 s44, s59, 1
    s_add_u32 s44, s44, 81920
    v_add_u32 v4, s44, v4
    s_lshl_b32 s44, s68, 10
    s_add_u32 s44, s44, s43
    v_add_u32 v253, s44, v15
    s_lshl_b32 s44, s68, 11
    v_add_u32 v5, s44, v4
    s_lshl_b32 s44, s69, 10
    s_add_u32 s44, s44, s43
    v_add_u32 v254, s44, v15
    s_lshl_b32 s44, s69, 11
    v_add_u32 v6, s44, v4
    s_lshl_b32 s44, s70, 10
    s_add_u32 s44, s44, s43
    v_add_u32 v255, s44, v15
    s_lshl_b32 s44, s70, 11
    v_add_u32 v7, s44, v4
    s_waitcnt vmcnt(12)
    ds_write_b128 v246, v[236:239]
    ds_write_b128 v247, v[240:243]
    s_waitcnt lgkmcnt(0)
    v_mfma_f32_16x16x32_bf16 v[212:215], v[72:75], v[16:19], 0
    v_mfma_f32_16x16x32_bf16 v[232:235], v[72:75], v[20:23], 0
    v_mfma_f32_16x16x32_bf16 v[216:219], v[76:79], v[16:19], 0
    v_mfma_f32_16x16x32_bf16 v[236:239], v[76:79], v[20:23], 0
    v_mfma_f32_16x16x32_bf16 v[220:223], v[80:83], v[16:19], 0
    v_mfma_f32_16x16x32_bf16 v[240:243], v[80:83], v[20:23], 0
    v_mfma_f32_16x16x32_bf16 v[224:227], v[84:87], v[16:19], 0
    v_mfma_f32_16x16x32_bf16 v[244:247], v[84:87], v[20:23], 0
    v_mfma_f32_16x16x32_bf16 v[228:231], v[88:91], v[16:19], 0
    v_mfma_f32_16x16x32_bf16 v[248:251], v[88:91], v[20:23], 0
    s_waitcnt vmcnt(10)
    v_mfma_f32_16x16x32_bf16 v[212:215], v[92:95], v[24:27], v[212:215]
    v_mfma_f32_16x16x32_bf16 v[232:235], v[92:95], v[28:31], v[232:235]
    v_mfma_f32_16x16x32_bf16 v[216:219], v[96:99], v[24:27], v[216:219]
    v_mfma_f32_16x16x32_bf16 v[236:239], v[96:99], v[28:31], v[236:239]
    v_mfma_f32_16x16x32_bf16 v[220:223], v[100:103], v[24:27], v[220:223]
    v_mfma_f32_16x16x32_bf16 v[240:243], v[100:103], v[28:31], v[240:243]
    v_mfma_f32_16x16x32_bf16 v[224:227], v[104:107], v[24:27], v[224:227]
    v_mfma_f32_16x16x32_bf16 v[244:247], v[104:107], v[28:31], v[244:247]
    v_mfma_f32_16x16x32_bf16 v[228:231], v[108:111], v[24:27], v[228:231]
    v_mfma_f32_16x16x32_bf16 v[248:251], v[108:111], v[28:31], v[248:251]
    s_waitcnt vmcnt(8)
    v_mfma_f32_16x16x32_bf16 v[212:215], v[112:115], v[32:35], v[212:215]
    v_mfma_f32_16x16x32_bf16 v[232:235], v[112:115], v[36:39], v[232:235]
    v_mfma_f32_16x16x32_bf16 v[216:219], v[116:119], v[32:35], v[216:219]
    v_mfma_f32_16x16x32_bf16 v[236:239], v[116:119], v[36:39], v[236:239]
    v_mfma_f32_16x16x32_bf16 v[220:223], v[120:123], v[32:35], v[220:223]
    v_mfma_f32_16x16x32_bf16 v[240:243], v[120:123], v[36:39], v[240:243]
    v_mfma_f32_16x16x32_bf16 v[224:227], v[124:127], v[32:35], v[224:227]
    v_mfma_f32_16x16x32_bf16 v[244:247], v[124:127], v[36:39], v[244:247]
    v_mfma_f32_16x16x32_bf16 v[228:231], v[128:131], v[32:35], v[228:231]
    v_mfma_f32_16x16x32_bf16 v[248:251], v[128:131], v[36:39], v[248:251]
    s_waitcnt vmcnt(6)
    v_mfma_f32_16x16x32_bf16 v[212:215], v[132:135], v[40:43], v[212:215]
    v_mfma_f32_16x16x32_bf16 v[232:235], v[132:135], v[44:47], v[232:235]
    v_mfma_f32_16x16x32_bf16 v[216:219], v[136:139], v[40:43], v[216:219]
    v_mfma_f32_16x16x32_bf16 v[236:239], v[136:139], v[44:47], v[236:239]
    v_mfma_f32_16x16x32_bf16 v[220:223], v[140:143], v[40:43], v[220:223]
    v_mfma_f32_16x16x32_bf16 v[240:243], v[140:143], v[44:47], v[240:243]
    v_mfma_f32_16x16x32_bf16 v[224:227], v[144:147], v[40:43], v[224:227]
    v_mfma_f32_16x16x32_bf16 v[244:247], v[144:147], v[44:47], v[244:247]
    v_mfma_f32_16x16x32_bf16 v[228:231], v[148:151], v[40:43], v[228:231]
    v_mfma_f32_16x16x32_bf16 v[248:251], v[148:151], v[44:47], v[248:251]
    s_waitcnt vmcnt(4)
    v_mfma_f32_16x16x32_bf16 v[212:215], v[152:155], v[48:51], v[212:215]
    v_mfma_f32_16x16x32_bf16 v[232:235], v[152:155], v[52:55], v[232:235]
    v_mfma_f32_16x16x32_bf16 v[216:219], v[156:159], v[48:51], v[216:219]
    v_mfma_f32_16x16x32_bf16 v[236:239], v[156:159], v[52:55], v[236:239]
    v_mfma_f32_16x16x32_bf16 v[220:223], v[160:163], v[48:51], v[220:223]
    v_mfma_f32_16x16x32_bf16 v[240:243], v[160:163], v[52:55], v[240:243]
    v_mfma_f32_16x16x32_bf16 v[224:227], v[164:167], v[48:51], v[224:227]
    v_mfma_f32_16x16x32_bf16 v[244:247], v[164:167], v[52:55], v[244:247]
    v_mfma_f32_16x16x32_bf16 v[228:231], v[168:171], v[48:51], v[228:231]
    v_mfma_f32_16x16x32_bf16 v[248:251], v[168:171], v[52:55], v[248:251]
    s_waitcnt vmcnt(2)
    v_mfma_f32_16x16x32_bf16 v[212:215], v[172:175], v[56:59], v[212:215]
    v_mfma_f32_16x16x32_bf16 v[232:235], v[172:175], v[60:63], v[232:235]
    v_mfma_f32_16x16x32_bf16 v[216:219], v[176:179], v[56:59], v[216:219]
    v_mfma_f32_16x16x32_bf16 v[236:239], v[176:179], v[60:63], v[236:239]
    v_mfma_f32_16x16x32_bf16 v[220:223], v[180:183], v[56:59], v[220:223]
    v_mfma_f32_16x16x32_bf16 v[240:243], v[180:183], v[60:63], v[240:243]
    v_mfma_f32_16x16x32_bf16 v[224:227], v[184:187], v[56:59], v[224:227]
    v_mfma_f32_16x16x32_bf16 v[244:247], v[184:187], v[60:63], v[244:247]
    v_mfma_f32_16x16x32_bf16 v[228:231], v[188:191], v[56:59], v[228:231]
    v_mfma_f32_16x16x32_bf16 v[248:251], v[188:191], v[60:63], v[248:251]
    s_waitcnt vmcnt(0)
    v_mfma_f32_16x16x32_bf16 v[212:215], v[192:195], v[64:67], v[212:215]
    v_mfma_f32_16x16x32_bf16 v[232:235], v[192:195], v[68:71], v[232:235]
    v_mfma_f32_16x16x32_bf16 v[216:219], v[196:199], v[64:67], v[216:219]
    v_mfma_f32_16x16x32_bf16 v[236:239], v[196:199], v[68:71], v[236:239]
    v_mfma_f32_16x16x32_bf16 v[220:223], v[200:203], v[64:67], v[220:223]
    v_mfma_f32_16x16x32_bf16 v[240:243], v[200:203], v[68:71], v[240:243]
    v_mfma_f32_16x16x32_bf16 v[224:227], v[204:207], v[64:67], v[224:227]
    v_mfma_f32_16x16x32_bf16 v[244:247], v[204:207], v[68:71], v[244:247]
    v_mfma_f32_16x16x32_bf16 v[228:231], v[208:211], v[64:67], v[228:231]
    v_mfma_f32_16x16x32_bf16 v[248:251], v[208:211], v[68:71], v[248:251]
    s_nop 2
    s_nop 1
    ds_write_b128 v252, v[212:215] offset:0
    ds_write_b128 v252, v[232:235] offset:5120
    ds_write_b128 v252, v[216:219] offset:1024
    ds_write_b128 v252, v[236:239] offset:6144
    ds_write_b128 v252, v[220:223] offset:2048
    ds_write_b128 v252, v[240:243] offset:7168
    ds_write_b128 v252, v[224:227] offset:3072
    ds_write_b128 v252, v[244:247] offset:8192
    ds_write_b128 v252, v[228:231] offset:4096
    ds_write_b128 v252, v[248:251] offset:9216
    v_lshlrev_b32 v96, 16, v8
    v_and_b32 v97, 0xffff0000, v8
    v_lshlrev_b32 v98, 16, v9
    v_and_b32 v99, 0xffff0000, v9
    v_lshlrev_b32 v100, 16, v10
    v_and_b32 v101, 0xffff0000, v10
    v_lshlrev_b32 v102, 16, v11
    v_and_b32 v103, 0xffff0000, v11
    v_lshlrev_b32 v104, 16, v12
    v_and_b32 v105, 0xffff0000, v12
    v_lshlrev_b32 v106, 16, v13
    v_and_b32 v107, 0xffff0000, v13
    s_waitcnt lgkmcnt(0)
    s_barrier
    ds_read_b64_tr_b16 v[24:25], v5
    ds_read_b64_tr_b16 v[26:27], v6
    ds_read_b64_tr_b16 v[28:29], v7
    ds_read_b128 v[32:35], v253 offset:0
    ds_read_b128 v[36:39], v253 offset:10240
    ds_read_b128 v[40:43], v253 offset:20480
    ds_read_b128 v[44:47], v253 offset:30720
    ds_read_b128 v[48:51], v254 offset:0
    ds_read_b128 v[52:55], v254 offset:10240
    ds_read_b128 v[56:59], v254 offset:20480
    ds_read_b128 v[60:63], v254 offset:30720
    ds_read_b128 v[64:67], v255 offset:0
    ds_read_b128 v[68:71], v255 offset:10240
    ds_read_b128 v[72:75], v255 offset:20480
    ds_read_b128 v[76:79], v255 offset:30720
    s_waitcnt lgkmcnt(12)
    v_lshlrev_b32 v112, 16, v24
    v_and_b32 v113, 0xffff0000, v24
    v_lshlrev_b32 v114, 16, v25
    v_and_b32 v115, 0xffff0000, v25
    v_lshlrev_b32 v116, 16, v26
    v_and_b32 v117, 0xffff0000, v26
    v_lshlrev_b32 v118, 16, v27
    v_and_b32 v119, 0xffff0000, v27
    v_lshlrev_b32 v120, 16, v28
    v_and_b32 v121, 0xffff0000, v28
    v_lshlrev_b32 v122, 16, v29
    v_and_b32 v123, 0xffff0000, v29
    v_pk_add_f32 v[96:97], v[96:97], v[112:113]
    v_pk_add_f32 v[98:99], v[98:99], v[114:115]
    v_pk_add_f32 v[100:101], v[100:101], v[116:117]
    v_pk_add_f32 v[102:103], v[102:103], v[118:119]
    v_pk_add_f32 v[104:105], v[104:105], v[120:121]
    v_pk_add_f32 v[106:107], v[106:107], v[122:123]
    s_waitcnt lgkmcnt(0)
    v_pk_add_f32 v[32:33], v[32:33], v[36:37]
    v_pk_add_f32 v[40:41], v[40:41], v[44:45]
    v_pk_add_f32 v[34:35], v[34:35], v[38:39]
    v_pk_add_f32 v[42:43], v[42:43], v[46:47]
    v_pk_add_f32 v[48:49], v[48:49], v[52:53]
    v_pk_add_f32 v[56:57], v[56:57], v[60:61]
    v_pk_add_f32 v[50:51], v[50:51], v[54:55]
    v_pk_add_f32 v[58:59], v[58:59], v[62:63]
    v_pk_add_f32 v[64:65], v[64:65], v[68:69]
    v_pk_add_f32 v[72:73], v[72:73], v[76:77]
    v_pk_add_f32 v[66:67], v[66:67], v[70:71]
    v_pk_add_f32 v[74:75], v[74:75], v[78:79]
    v_pk_add_f32 v[32:33], v[32:33], v[40:41]
    v_pk_add_f32 v[34:35], v[34:35], v[42:43]
    v_pk_add_f32 v[48:49], v[48:49], v[56:57]
    v_pk_add_f32 v[50:51], v[50:51], v[58:59]
    v_pk_add_f32 v[64:65], v[64:65], v[72:73]
    v_pk_add_f32 v[66:67], v[66:67], v[74:75]
    v_pk_add_f32 v[32:33], v[32:33], v[96:97]
    v_pk_add_f32 v[34:35], v[34:35], v[98:99]
    v_pk_add_f32 v[48:49], v[48:49], v[100:101]
    v_pk_add_f32 v[50:51], v[50:51], v[102:103]
    v_pk_add_f32 v[64:65], v[64:65], v[104:105]
    v_pk_add_f32 v[66:67], v[66:67], v[106:107]
    v_cvt_pk_bf16_f32 v24, v32, v33
    v_cvt_pk_bf16_f32 v25, v34, v35
    v_cvt_pk_bf16_f32 v26, v48, v49
    v_cvt_pk_bf16_f32 v27, v50, v51
    v_cvt_pk_bf16_f32 v28, v64, v65
    v_cvt_pk_bf16_f32 v29, v66, v67
    buffer_store_dwordx2 v[24:25], v14, s[28:31], s72 offen
    buffer_store_dwordx2 v[26:27], v14, s[28:31], s73 offen
    buffer_store_dwordx2 v[28:29], v14, s[28:31], s74 offen
    s_lshl_b32 s43, s2, 3
    s_add_u32 s43, s43, s32
    s_cmp_lg_u32 s43, 4
    s_cbranch_scc1 m_fin
    s_mov_b32 s64, s12
    s_mov_b32 s65, s13
    s_mov_b32 s66, 256
    s_mov_b32 s67, 0x00020000
    v_mov_b32 v4, 0
    s_mov_b64 exec, 1
    buffer_store_dword v4, v4, s[64:67], 0 offen sc1
m_fin:
    s_endpgm
m_helper:
    s_lshl_b32 s35, s41, 2
    s_add_u32 s35, s35, s42
    s_sub_u32 s35, s35, 28
    v_and_b32 v2, 15, v1
    v_lshrrev_b32 v3, 4, v1
    s_lshl_b32 s43, s32, 3
    v_add_u32 v4, s43, v3
    s_lshl_b32 s44, s35, 6
    v_add_u32 v5, s44, v4
    v_mul_u32_u24 v5, 1280, v5
    v_lshl_add_u32 v5, v2, 4, v5
    v_add_u32 v6, 5120, v5
    v_mul_u32_u24 v7, 1296, v4
    v_lshl_add_u32 v7, v2, 4, v7
    v_mov_b32 v110, 0
    v_and_b32 v4, 31, v1
    v_lshlrev_b32 v4, 2, v4
    v_add_u32 v4, 163712, v4
    s_cmp_lg_u32 s32, 4
    s_cbranch_scc1 m_hnoclr
    ds_write_b32 v4, v110
m_hnoclr:
    s_waitcnt lgkmcnt(0)
    s_mov_b32 s16, s4
    s_mov_b32 s17, s5
    s_mov_b32 s18, 2621440
    s_mov_b32 s19, 0x00020000
    s_mov_b32 s28, s14
    s_mov_b32 s29, s15
    s_mov_b32 s30, 2621440
    s_mov_b32 s31, 0x00020000
    s_mov_b32 s64, s12
    s_mov_b32 s65, s13
    s_mov_b32 s66, 256
    s_mov_b32 s67, 0x00020000
    s_add_u32 s60, s14, 25165824
    s_addc_u32 s61, s15, 0
    s_mov_b32 s62, 262144
    s_mov_b32 s63, 0x00020000
    s_mov_b32 s20, s96
    s_mov_b32 s21, s97
    s_mov_b32 s22, 1105920
    s_mov_b32 s23, 0x00020000
    buffer_load_dwordx4 v[8:11], v5, s[16:19], 0 offen offset:0
    buffer_load_dwordx4 v[12:15], v5, s[16:19], 0 offen offset:256
    buffer_load_dwordx4 v[16:19], v5, s[16:19], 0 offen offset:512
    buffer_load_dwordx4 v[20:23], v5, s[16:19], 0 offen offset:768
    buffer_load_dwordx4 v[24:27], v5, s[16:19], 0 offen offset:1024
    buffer_load_dwordx4 v[28:31], v6, s[16:19], 0 offen offset:0
    buffer_load_dwordx4 v[32:35], v6, s[16:19], 0 offen offset:256
    buffer_load_dwordx4 v[36:39], v6, s[16:19], 0 offen offset:512
    buffer_load_dwordx4 v[40:43], v6, s[16:19], 0 offen offset:768
    buffer_load_dwordx4 v[44:47], v6, s[16:19], 0 offen offset:1024
    s_waitcnt vmcnt(5)
    buffer_load_dword v111, v110, s[64:67], 0 offen sc1
    v_lshlrev_b32 v48, 16, v8
    v_and_b32 v49, 0xffff0000, v8
    v_lshlrev_b32 v50, 16, v9
    v_and_b32 v51, 0xffff0000, v9
    v_lshlrev_b32 v52, 16, v10
    v_and_b32 v53, 0xffff0000, v10
    v_lshlrev_b32 v54, 16, v11
    v_and_b32 v55, 0xffff0000, v11
    v_lshlrev_b32 v56, 16, v12
    v_and_b32 v57, 0xffff0000, v12
    v_lshlrev_b32 v58, 16, v13
    v_and_b32 v59, 0xffff0000, v13
    v_lshlrev_b32 v60, 16, v14
    v_and_b32 v61, 0xffff0000, v14
    v_lshlrev_b32 v62, 16, v15
    v_and_b32 v63, 0xffff0000, v15
    v_lshlrev_b32 v64, 16, v16
    v_and_b32 v65, 0xffff0000, v16
    v_lshlrev_b32 v66, 16, v17
    v_and_b32 v67, 0xffff0000, v17
    v_lshlrev_b32 v68, 16, v18
    v_and_b32 v69, 0xffff0000, v18
    v_lshlrev_b32 v70, 16, v19
    v_and_b32 v71, 0xffff0000, v19
    v_lshlrev_b32 v72, 16, v20
    v_and_b32 v73, 0xffff0000, v20
    v_lshlrev_b32 v74, 16, v21
    v_and_b32 v75, 0xffff0000, v21
    v_lshlrev_b32 v76, 16, v22
    v_and_b32 v77, 0xffff0000, v22
    v_lshlrev_b32 v78, 16, v23
    v_and_b32 v79, 0xffff0000, v23
    v_lshlrev_b32 v80, 16, v24
    v_and_b32 v81, 0xffff0000, v24
    v_lshlrev_b32 v82, 16, v25
    v_and_b32 v83, 0xffff0000, v25
    v_lshlrev_b32 v84, 16, v26
    v_and_b32 v85, 0xffff0000, v26
    v_lshlrev_b32 v86, 16, v27
    v_and_b32 v87, 0xffff0000, v27
    v_pk_add_f32 v[88:89], v[48:49], v[52:53]
    v_pk_add_f32 v[90:91], v[50:51], v[54:55]
    v_pk_add_f32 v[88:89], v[88:89], v[56:57]
    v_pk_add_f32 v[90:91], v[90:91], v[58:59]
    v_pk_add_f32 v[88:89], v[88:89], v[60:61]
    v_pk_add_f32 v[90:91], v[90:91], v[62:63]
    v_pk_add_f32 v[88:89], v[88:89], v[64:65]
    v_pk_add_f32 v[90:91], v[90:91], v[66:67]
    v_pk_add_f32 v[88:89], v[88:89], v[68:69]
    v_pk_add_f32 v[90:91], v[90:91], v[70:71]
    v_pk_add_f32 v[88:89], v[88:89], v[72:73]
    v_pk_add_f32 v[90:91], v[90:91], v[74:75]
    v_pk_add_f32 v[88:89], v[88:89], v[76:77]
    v_pk_add_f32 v[90:91], v[90:91], v[78:79]
    v_pk_add_f32 v[88:89], v[88:89], v[80:81]
    v_pk_add_f32 v[90:91], v[90:91], v[82:83]
    v_pk_add_f32 v[88:89], v[88:89], v[84:85]
    v_pk_add_f32 v[90:91], v[90:91], v[86:87]
    v_pk_add_f32 v[88:89], v[88:89], v[90:91]
    s_nop 0
    v_add_f32 v88, v88, v89
    s_nop 1
    v_add_f32_dpp v88, v88, v88 row_ror:8 row_mask:0xf bank_mask:0xf
    s_nop 1
    v_add_f32_dpp v88, v88, v88 row_ror:4 row_mask:0xf bank_mask:0xf
    s_nop 1
    v_add_f32_dpp v88, v88, v88 row_ror:2 row_mask:0xf bank_mask:0xf
    s_nop 1
    v_add_f32_dpp v88, v88, v88 row_ror:1 row_mask:0xf bank_mask:0xf
    v_mul_f32 v112, 0x3acccccd, v88
    v_mov_b32 v92, 0
    v_mov_b32 v93, 0
    v_mov_b32 v94, 0
    v_mov_b32 v95, 0
    v_pk_add_f32 v[96:97], v[48:49], v[112:113] op_sel_hi:[1,0] neg_lo:[0,1] neg_hi:[0,1]
    v_pk_add_f32 v[98:99], v[50:51], v[112:113] op_sel_hi:[1,0] neg_lo:[0,1] neg_hi:[0,1]
    v_pk_add_f32 v[100:101], v[52:53], v[112:113] op_sel_hi:[1,0] neg_lo:[0,1] neg_hi:[0,1]
    v_pk_add_f32 v[102:103], v[54:55], v[112:113] op_sel_hi:[1,0] neg_lo:[0,1] neg_hi:[0,1]
    v_pk_fma_f32 v[92:93], v[96:97], v[96:97], v[92:93]
    v_pk_fma_f32 v[94:95], v[98:99], v[98:99], v[94:95]
    v_pk_fma_f32 v[92:93], v[100:101], v[100:101], v[92:93]
    v_pk_fma_f32 v[94:95], v[102:103], v[102:103], v[94:95]
    v_pk_add_f32 v[96:97], v[56:57], v[112:113] op_sel_hi:[1,0] neg_lo:[0,1] neg_hi:[0,1]
    v_pk_add_f32 v[98:99], v[58:59], v[112:113] op_sel_hi:[1,0] neg_lo:[0,1] neg_hi:[0,1]
    v_pk_add_f32 v[100:101], v[60:61], v[112:113] op_sel_hi:[1,0] neg_lo:[0,1] neg_hi:[0,1]
    v_pk_add_f32 v[102:103], v[62:63], v[112:113] op_sel_hi:[1,0] neg_lo:[0,1] neg_hi:[0,1]
    v_pk_fma_f32 v[92:93], v[96:97], v[96:97], v[92:93]
    v_pk_fma_f32 v[94:95], v[98:99], v[98:99], v[94:95]
    v_pk_fma_f32 v[92:93], v[100:101], v[100:101], v[92:93]
    v_pk_fma_f32 v[94:95], v[102:103], v[102:103], v[94:95]
    v_pk_add_f32 v[96:97], v[64:65], v[112:113] op_sel_hi:[1,0] neg_lo:[0,1] neg_hi:[0,1]
    v_pk_add_f32 v[98:99], v[66:67], v[112:113] op_sel_hi:[1,0] neg_lo:[0,1] neg_hi:[0,1]
    v_pk_add_f32 v[100:101], v[68:69], v[112:113] op_sel_hi:[1,0] neg_lo:[0,1] neg_hi:[0,1]
    v_pk_add_f32 v[102:103], v[70:71], v[112:113] op_sel_hi:[1,0] neg_lo:[0,1] neg_hi:[0,1]
    v_pk_fma_f32 v[92:93], v[96:97], v[96:97], v[92:93]
    v_pk_fma_f32 v[94:95], v[98:99], v[98:99], v[94:95]
    v_pk_fma_f32 v[92:93], v[100:101], v[100:101], v[92:93]
    v_pk_fma_f32 v[94:95], v[102:103], v[102:103], v[94:95]
    v_pk_add_f32 v[96:97], v[72:73], v[112:113] op_sel_hi:[1,0] neg_lo:[0,1] neg_hi:[0,1]
    v_pk_add_f32 v[98:99], v[74:75], v[112:113] op_sel_hi:[1,0] neg_lo:[0,1] neg_hi:[0,1]
    v_pk_add_f32 v[100:101], v[76:77], v[112:113] op_sel_hi:[1,0] neg_lo:[0,1] neg_hi:[0,1]
    v_pk_add_f32 v[102:103], v[78:79], v[112:113] op_sel_hi:[1,0] neg_lo:[0,1] neg_hi:[0,1]
    v_pk_fma_f32 v[92:93], v[96:97], v[96:97], v[92:93]
    v_pk_fma_f32 v[94:95], v[98:99], v[98:99], v[94:95]
    v_pk_fma_f32 v[92:93], v[100:101], v[100:101], v[92:93]
    v_pk_fma_f32 v[94:95], v[102:103], v[102:103], v[94:95]
    v_pk_add_f32 v[96:97], v[80:81], v[112:113] op_sel_hi:[1,0] neg_lo:[0,1] neg_hi:[0,1]
    v_pk_add_f32 v[98:99], v[82:83], v[112:113] op_sel_hi:[1,0] neg_lo:[0,1] neg_hi:[0,1]
    v_pk_add_f32 v[100:101], v[84:85], v[112:113] op_sel_hi:[1,0] neg_lo:[0,1] neg_hi:[0,1]
    v_pk_add_f32 v[102:103], v[86:87], v[112:113] op_sel_hi:[1,0] neg_lo:[0,1] neg_hi:[0,1]
    v_pk_fma_f32 v[92:93], v[96:97], v[96:97], v[92:93]
    v_pk_fma_f32 v[94:95], v[98:99], v[98:99], v[94:95]
    v_pk_fma_f32 v[92:93], v[100:101], v[100:101], v[92:93]
    v_pk_fma_f32 v[94:95], v[102:103], v[102:103], v[94:95]
    v_pk_add_f32 v[92:93], v[92:93], v[94:95]
    s_nop 0
    v_add_f32 v92, v92, v93
    s_nop 1
    v_add_f32_dpp v92, v92, v92 row_ror:8 row_mask:0xf bank_mask:0xf
    s_nop 1
    v_add_f32_dpp v92, v92, v92 row_ror:4 row_mask:0xf bank_mask:0xf
    s_nop 1
    v_add_f32_dpp v92, v92, v92 row_ror:2 row_mask:0xf bank_mask:0xf
    s_nop 1
    v_add_f32_dpp v92, v92, v92 row_ror:1 row_mask:0xf bank_mask:0xf
    v_mul_f32 v114, 0x3acccccd, v92
    v_max_f32 v114, 0, v114
    v_cvt_pk_bf16_f32 v89, v112, v114
    v_lshlrev_b32 v112, 16, v89
    v_and_b32 v114, 0xffff0000, v89
    v_add_f32 v114, 0x3727c5ac, v114
    v_cvt_pk_bf16_f32 v89, v114, v114
    v_and_b32 v114, 0xffff0000, v89
    v_sqrt_f32 v114, v114
    s_nop 0
    v_cvt_pk_bf16_f32 v89, v114, v114
    v_and_b32 v114, 0xffff0000, v89
    v_rcp_f32 v114, v114
    s_nop 0
    s_waitcnt vmcnt(1)
    v_lshlrev_b32 v128, 16, v28
    v_and_b32 v129, 0xffff0000, v28
    v_lshlrev_b32 v130, 16, v29
    v_and_b32 v131, 0xffff0000, v29
    v_lshlrev_b32 v132, 16, v30
    v_and_b32 v133, 0xffff0000, v30
    v_lshlrev_b32 v134, 16, v31
    v_and_b32 v135, 0xffff0000, v31
    v_lshlrev_b32 v136, 16, v32
    v_and_b32 v137, 0xffff0000, v32
    v_lshlrev_b32 v138, 16, v33
    v_and_b32 v139, 0xffff0000, v33
    v_lshlrev_b32 v140, 16, v34
    v_and_b32 v141, 0xffff0000, v34
    v_lshlrev_b32 v142, 16, v35
    v_and_b32 v143, 0xffff0000, v35
    v_lshlrev_b32 v144, 16, v36
    v_and_b32 v145, 0xffff0000, v36
    v_lshlrev_b32 v146, 16, v37
    v_and_b32 v147, 0xffff0000, v37
    v_lshlrev_b32 v148, 16, v38
    v_and_b32 v149, 0xffff0000, v38
    v_lshlrev_b32 v150, 16, v39
    v_and_b32 v151, 0xffff0000, v39
    v_lshlrev_b32 v152, 16, v40
    v_and_b32 v153, 0xffff0000, v40
    v_lshlrev_b32 v154, 16, v41
    v_and_b32 v155, 0xffff0000, v41
    v_lshlrev_b32 v156, 16, v42
    v_and_b32 v157, 0xffff0000, v42
    v_lshlrev_b32 v158, 16, v43
    v_and_b32 v159, 0xffff0000, v43
    v_lshlrev_b32 v160, 16, v44
    v_and_b32 v161, 0xffff0000, v44
    v_lshlrev_b32 v162, 16, v45
    v_and_b32 v163, 0xffff0000, v45
    v_lshlrev_b32 v164, 16, v46
    v_and_b32 v165, 0xffff0000, v46
    v_lshlrev_b32 v166, 16, v47
    v_and_b32 v167, 0xffff0000, v47
    v_pk_add_f32 v[88:89], v[128:129], v[132:133]
    v_pk_add_f32 v[90:91], v[130:131], v[134:135]
    v_pk_add_f32 v[88:89], v[88:89], v[136:137]
    v_pk_add_f32 v[90:91], v[90:91], v[138:139]
    v_pk_add_f32 v[88:89], v[88:89], v[140:141]
    v_pk_add_f32 v[90:91], v[90:91], v[142:143]
    v_pk_add_f32 v[88:89], v[88:89], v[144:145]
    v_pk_add_f32 v[90:91], v[90:91], v[146:147]
    v_pk_add_f32 v[88:89], v[88:89], v[148:149]
    v_pk_add_f32 v[90:91], v[90:91], v[150:151]
    v_pk_add_f32 v[88:89], v[88:89], v[152:153]
    v_pk_add_f32 v[90:91], v[90:91], v[154:155]
    v_pk_add_f32 v[88:89], v[88:89], v[156:157]
    v_pk_add_f32 v[90:91], v[90:91], v[158:159]
    v_pk_add_f32 v[88:89], v[88:89], v[160:161]
    v_pk_add_f32 v[90:91], v[90:91], v[162:163]
    v_pk_add_f32 v[88:89], v[88:89], v[164:165]
    v_pk_add_f32 v[90:91], v[90:91], v[166:167]
    v_pk_add_f32 v[88:89], v[88:89], v[90:91]
    s_nop 0
    v_add_f32 v88, v88, v89
    s_nop 1
    v_add_f32_dpp v88, v88, v88 row_ror:8 row_mask:0xf bank_mask:0xf
    s_nop 1
    v_add_f32_dpp v88, v88, v88 row_ror:4 row_mask:0xf bank_mask:0xf
    s_nop 1
    v_add_f32_dpp v88, v88, v88 row_ror:2 row_mask:0xf bank_mask:0xf
    s_nop 1
    v_add_f32_dpp v88, v88, v88 row_ror:1 row_mask:0xf bank_mask:0xf
    v_mul_f32 v116, 0x3acccccd, v88
    v_mov_b32 v92, 0
    v_mov_b32 v93, 0
    v_mov_b32 v94, 0
    v_mov_b32 v95, 0
    v_pk_add_f32 v[96:97], v[128:129], v[116:117] op_sel_hi:[1,0] neg_lo:[0,1] neg_hi:[0,1]
    v_pk_add_f32 v[98:99], v[130:131], v[116:117] op_sel_hi:[1,0] neg_lo:[0,1] neg_hi:[0,1]
    v_pk_add_f32 v[100:101], v[132:133], v[116:117] op_sel_hi:[1,0] neg_lo:[0,1] neg_hi:[0,1]
    v_pk_add_f32 v[102:103], v[134:135], v[116:117] op_sel_hi:[1,0] neg_lo:[0,1] neg_hi:[0,1]
    v_pk_fma_f32 v[92:93], v[96:97], v[96:97], v[92:93]
    v_pk_fma_f32 v[94:95], v[98:99], v[98:99], v[94:95]
    v_pk_fma_f32 v[92:93], v[100:101], v[100:101], v[92:93]
    v_pk_fma_f32 v[94:95], v[102:103], v[102:103], v[94:95]
    v_pk_add_f32 v[96:97], v[136:137], v[116:117] op_sel_hi:[1,0] neg_lo:[0,1] neg_hi:[0,1]
    v_pk_add_f32 v[98:99], v[138:139], v[116:117] op_sel_hi:[1,0] neg_lo:[0,1] neg_hi:[0,1]
    v_pk_add_f32 v[100:101], v[140:141], v[116:117] op_sel_hi:[1,0] neg_lo:[0,1] neg_hi:[0,1]
    v_pk_add_f32 v[102:103], v[142:143], v[116:117] op_sel_hi:[1,0] neg_lo:[0,1] neg_hi:[0,1]
    v_pk_fma_f32 v[92:93], v[96:97], v[96:97], v[92:93]
    v_pk_fma_f32 v[94:95], v[98:99], v[98:99], v[94:95]
    v_pk_fma_f32 v[92:93], v[100:101], v[100:101], v[92:93]
    v_pk_fma_f32 v[94:95], v[102:103], v[102:103], v[94:95]
    v_pk_add_f32 v[96:97], v[144:145], v[116:117] op_sel_hi:[1,0] neg_lo:[0,1] neg_hi:[0,1]
    v_pk_add_f32 v[98:99], v[146:147], v[116:117] op_sel_hi:[1,0] neg_lo:[0,1] neg_hi:[0,1]
    v_pk_add_f32 v[100:101], v[148:149], v[116:117] op_sel_hi:[1,0] neg_lo:[0,1] neg_hi:[0,1]
    v_pk_add_f32 v[102:103], v[150:151], v[116:117] op_sel_hi:[1,0] neg_lo:[0,1] neg_hi:[0,1]
    v_pk_fma_f32 v[92:93], v[96:97], v[96:97], v[92:93]
    v_pk_fma_f32 v[94:95], v[98:99], v[98:99], v[94:95]
    v_pk_fma_f32 v[92:93], v[100:101], v[100:101], v[92:93]
    v_pk_fma_f32 v[94:95], v[102:103], v[102:103], v[94:95]
    v_pk_add_f32 v[96:97], v[152:153], v[116:117] op_sel_hi:[1,0] neg_lo:[0,1] neg_hi:[0,1]
    v_pk_add_f32 v[98:99], v[154:155], v[116:117] op_sel_hi:[1,0] neg_lo:[0,1] neg_hi:[0,1]
    v_pk_add_f32 v[100:101], v[156:157], v[116:117] op_sel_hi:[1,0] neg_lo:[0,1] neg_hi:[0,1]
    v_pk_add_f32 v[102:103], v[158:159], v[116:117] op_sel_hi:[1,0] neg_lo:[0,1] neg_hi:[0,1]
    v_pk_fma_f32 v[92:93], v[96:97], v[96:97], v[92:93]
    v_pk_fma_f32 v[94:95], v[98:99], v[98:99], v[94:95]
    v_pk_fma_f32 v[92:93], v[100:101], v[100:101], v[92:93]
    v_pk_fma_f32 v[94:95], v[102:103], v[102:103], v[94:95]
    v_pk_add_f32 v[96:97], v[160:161], v[116:117] op_sel_hi:[1,0] neg_lo:[0,1] neg_hi:[0,1]
    v_pk_add_f32 v[98:99], v[162:163], v[116:117] op_sel_hi:[1,0] neg_lo:[0,1] neg_hi:[0,1]
    v_pk_add_f32 v[100:101], v[164:165], v[116:117] op_sel_hi:[1,0] neg_lo:[0,1] neg_hi:[0,1]
    v_pk_add_f32 v[102:103], v[166:167], v[116:117] op_sel_hi:[1,0] neg_lo:[0,1] neg_hi:[0,1]
    v_pk_fma_f32 v[92:93], v[96:97], v[96:97], v[92:93]
    v_pk_fma_f32 v[94:95], v[98:99], v[98:99], v[94:95]
    v_pk_fma_f32 v[92:93], v[100:101], v[100:101], v[92:93]
    v_pk_fma_f32 v[94:95], v[102:103], v[102:103], v[94:95]
    v_pk_add_f32 v[92:93], v[92:93], v[94:95]
    s_nop 0
    v_add_f32 v92, v92, v93
    s_nop 1
    v_add_f32_dpp v92, v92, v92 row_ror:8 row_mask:0xf bank_mask:0xf
    s_nop 1
    v_add_f32_dpp v92, v92, v92 row_ror:4 row_mask:0xf bank_mask:0xf
    s_nop 1
    v_add_f32_dpp v92, v92, v92 row_ror:2 row_mask:0xf bank_mask:0xf
    s_nop 1
    v_add_f32_dpp v92, v92, v92 row_ror:1 row_mask:0xf bank_mask:0xf
    v_mul_f32 v118, 0x3acccccd, v92
    v_max_f32 v118, 0, v118
    v_cvt_pk_bf16_f32 v89, v116, v118
    v_lshlrev_b32 v116, 16, v89
    v_and_b32 v118, 0xffff0000, v89
    v_add_f32 v118, 0x3727c5ac, v118
    v_cvt_pk_bf16_f32 v89, v118, v118
    v_and_b32 v118, 0xffff0000, v89
    v_sqrt_f32 v118, v118
    s_nop 0
    v_cvt_pk_bf16_f32 v89, v118, v118
    v_and_b32 v118, 0xffff0000, v89
    v_rcp_f32 v118, v118
    s_nop 0
    s_mov_b32 s40, 0
m_hep:
    s_waitcnt vmcnt(0)
    v_readfirstlane_b32 s3, v111
    s_add_u32 s40, s40, 1
    s_cmp_lg_u32 s3, 0
    s_cbranch_scc1 m_hepok
    buffer_load_dword v111, v110, s[64:67], 0 offen sc1
    s_cmp_lt_u32 s40, 262144
    s_cbranch_scc1 m_hep
m_hepok:
    s_add_u32 s24, s14, 28311552
    s_addc_u32 s25, s15, 0
    s_mov_b32 s26, 32768
    s_mov_b32 s27, 0x00020000
    v_mov_b32 v113, v111
    v_mov_b32 v115, v111
    v_mov_b32 v117, v111
    v_mov_b32 v119, v111
    s_lshl_b32 s43, s35, 10
    s_lshl_b32 s44, s32, 7
    s_add_u32 s43, s43, s44
    v_lshlrev_b32 v5, 4, v3
    v_cmp_eq_u32 vcc, 0, v2
    s_and_saveexec_b64 s[44:45], vcc
    buffer_store_dwordx4 v[112:115], v5, s[24:27], s43 offen sc1
    buffer_store_dwordx4 v[116:119], v5, s[24:27], s43 offen offset:64 sc1
    s_mov_b64 exec, -1
    v_lshlrev_b32 v120, 4, v1
    s_lshl_b32 s43, s35, 3
    s_add_u32 s43, s43, s32
    s_mul_i32 s43, s43, 4352
    buffer_load_dwordx4 v[124:127], v120, s[20:23], s43 offen offset:0
    buffer_load_dwordx4 v[124:127], v120, s[20:23], s43 offen offset:1024
    buffer_load_dwordx4 v[124:127], v120, s[20:23], s43 offen offset:2048
    buffer_load_dwordx4 v[124:127], v120, s[20:23], s43 offen offset:3072
    s_add_u32 s43, s43, 4096
    buffer_load_dwordx4 v[124:127], v120, s[20:23], s43 offen
    v_pk_add_f32 v[48:49], v[48:49], v[112:113] op_sel_hi:[1,0] neg_lo:[0,1] neg_hi:[0,1]
    v_pk_add_f32 v[50:51], v[50:51], v[112:113] op_sel_hi:[1,0] neg_lo:[0,1] neg_hi:[0,1]
    v_pk_add_f32 v[52:53], v[52:53], v[112:113] op_sel_hi:[1,0] neg_lo:[0,1] neg_hi:[0,1]
    v_pk_add_f32 v[54:55], v[54:55], v[112:113] op_sel_hi:[1,0] neg_lo:[0,1] neg_hi:[0,1]
    v_pk_add_f32 v[56:57], v[56:57], v[112:113] op_sel_hi:[1,0] neg_lo:[0,1] neg_hi:[0,1]
    v_pk_add_f32 v[58:59], v[58:59], v[112:113] op_sel_hi:[1,0] neg_lo:[0,1] neg_hi:[0,1]
    v_pk_add_f32 v[60:61], v[60:61], v[112:113] op_sel_hi:[1,0] neg_lo:[0,1] neg_hi:[0,1]
    v_pk_add_f32 v[62:63], v[62:63], v[112:113] op_sel_hi:[1,0] neg_lo:[0,1] neg_hi:[0,1]
    v_pk_add_f32 v[64:65], v[64:65], v[112:113] op_sel_hi:[1,0] neg_lo:[0,1] neg_hi:[0,1]
    v_pk_add_f32 v[66:67], v[66:67], v[112:113] op_sel_hi:[1,0] neg_lo:[0,1] neg_hi:[0,1]
    v_pk_add_f32 v[68:69], v[68:69], v[112:113] op_sel_hi:[1,0] neg_lo:[0,1] neg_hi:[0,1]
    v_pk_add_f32 v[70:71], v[70:71], v[112:113] op_sel_hi:[1,0] neg_lo:[0,1] neg_hi:[0,1]
    v_pk_add_f32 v[72:73], v[72:73], v[112:113] op_sel_hi:[1,0] neg_lo:[0,1] neg_hi:[0,1]
    v_pk_add_f32 v[74:75], v[74:75], v[112:113] op_sel_hi:[1,0] neg_lo:[0,1] neg_hi:[0,1]
    v_pk_add_f32 v[76:77], v[76:77], v[112:113] op_sel_hi:[1,0] neg_lo:[0,1] neg_hi:[0,1]
    v_pk_add_f32 v[78:79], v[78:79], v[112:113] op_sel_hi:[1,0] neg_lo:[0,1] neg_hi:[0,1]
    v_pk_add_f32 v[80:81], v[80:81], v[112:113] op_sel_hi:[1,0] neg_lo:[0,1] neg_hi:[0,1]
    v_pk_add_f32 v[82:83], v[82:83], v[112:113] op_sel_hi:[1,0] neg_lo:[0,1] neg_hi:[0,1]
    v_pk_add_f32 v[84:85], v[84:85], v[112:113] op_sel_hi:[1,0] neg_lo:[0,1] neg_hi:[0,1]
    v_pk_add_f32 v[86:87], v[86:87], v[112:113] op_sel_hi:[1,0] neg_lo:[0,1] neg_hi:[0,1]
    v_pk_mul_f32 v[48:49], v[48:49], v[114:115] op_sel_hi:[1,0]
    v_pk_mul_f32 v[50:51], v[50:51], v[114:115] op_sel_hi:[1,0]
    v_pk_mul_f32 v[52:53], v[52:53], v[114:115] op_sel_hi:[1,0]
    v_pk_mul_f32 v[54:55], v[54:55], v[114:115] op_sel_hi:[1,0]
    v_pk_mul_f32 v[56:57], v[56:57], v[114:115] op_sel_hi:[1,0]
    v_pk_mul_f32 v[58:59], v[58:59], v[114:115] op_sel_hi:[1,0]
    v_pk_mul_f32 v[60:61], v[60:61], v[114:115] op_sel_hi:[1,0]
    v_pk_mul_f32 v[62:63], v[62:63], v[114:115] op_sel_hi:[1,0]
    v_pk_mul_f32 v[64:65], v[64:65], v[114:115] op_sel_hi:[1,0]
    v_pk_mul_f32 v[66:67], v[66:67], v[114:115] op_sel_hi:[1,0]
    v_pk_mul_f32 v[68:69], v[68:69], v[114:115] op_sel_hi:[1,0]
    v_pk_mul_f32 v[70:71], v[70:71], v[114:115] op_sel_hi:[1,0]
    v_pk_mul_f32 v[72:73], v[72:73], v[114:115] op_sel_hi:[1,0]
    v_pk_mul_f32 v[74:75], v[74:75], v[114:115] op_sel_hi:[1,0]
    v_pk_mul_f32 v[76:77], v[76:77], v[114:115] op_sel_hi:[1,0]
    v_pk_mul_f32 v[78:79], v[78:79], v[114:115] op_sel_hi:[1,0]
    v_pk_mul_f32 v[80:81], v[80:81], v[114:115] op_sel_hi:[1,0]
    v_pk_mul_f32 v[82:83], v[82:83], v[114:115] op_sel_hi:[1,0]
    v_pk_mul_f32 v[84:85], v[84:85], v[114:115] op_sel_hi:[1,0]
    v_pk_mul_f32 v[86:87], v[86:87], v[114:115] op_sel_hi:[1,0]
    v_cvt_pk_bf16_f32 v8, v48, v49
    v_cvt_pk_bf16_f32 v9, v50, v51
    v_cvt_pk_bf16_f32 v10, v52, v53
    v_cvt_pk_bf16_f32 v11, v54, v55
    v_cvt_pk_bf16_f32 v12, v56, v57
    v_cvt_pk_bf16_f32 v13, v58, v59
    v_cvt_pk_bf16_f32 v14, v60, v61
    v_cvt_pk_bf16_f32 v15, v62, v63
    v_cvt_pk_bf16_f32 v16, v64, v65
    v_cvt_pk_bf16_f32 v17, v66, v67
    v_cvt_pk_bf16_f32 v18, v68, v69
    v_cvt_pk_bf16_f32 v19, v70, v71
    v_cvt_pk_bf16_f32 v20, v72, v73
    v_cvt_pk_bf16_f32 v21, v74, v75
    v_cvt_pk_bf16_f32 v22, v76, v77
    v_cvt_pk_bf16_f32 v23, v78, v79
    v_cvt_pk_bf16_f32 v24, v80, v81
    v_cvt_pk_bf16_f32 v25, v82, v83
    v_cvt_pk_bf16_f32 v26, v84, v85
    v_cvt_pk_bf16_f32 v27, v86, v87
    ds_write_b128 v7, v[8:11] offset:0
    ds_write_b128 v7, v[12:15] offset:256
    ds_write_b128 v7, v[16:19] offset:512
    ds_write_b128 v7, v[20:23] offset:768
    ds_write_b128 v7, v[24:27] offset:1024
    v_pk_add_f32 v[128:129], v[128:129], v[116:117] op_sel_hi:[1,0] neg_lo:[0,1] neg_hi:[0,1]
    v_pk_add_f32 v[130:131], v[130:131], v[116:117] op_sel_hi:[1,0] neg_lo:[0,1] neg_hi:[0,1]
    v_pk_add_f32 v[132:133], v[132:133], v[116:117] op_sel_hi:[1,0] neg_lo:[0,1] neg_hi:[0,1]
    v_pk_add_f32 v[134:135], v[134:135], v[116:117] op_sel_hi:[1,0] neg_lo:[0,1] neg_hi:[0,1]
    v_pk_add_f32 v[136:137], v[136:137], v[116:117] op_sel_hi:[1,0] neg_lo:[0,1] neg_hi:[0,1]
    v_pk_add_f32 v[138:139], v[138:139], v[116:117] op_sel_hi:[1,0] neg_lo:[0,1] neg_hi:[0,1]
    v_pk_add_f32 v[140:141], v[140:141], v[116:117] op_sel_hi:[1,0] neg_lo:[0,1] neg_hi:[0,1]
    v_pk_add_f32 v[142:143], v[142:143], v[116:117] op_sel_hi:[1,0] neg_lo:[0,1] neg_hi:[0,1]
    v_pk_add_f32 v[144:145], v[144:145], v[116:117] op_sel_hi:[1,0] neg_lo:[0,1] neg_hi:[0,1]
    v_pk_add_f32 v[146:147], v[146:147], v[116:117] op_sel_hi:[1,0] neg_lo:[0,1] neg_hi:[0,1]
    v_pk_add_f32 v[148:149], v[148:149], v[116:117] op_sel_hi:[1,0] neg_lo:[0,1] neg_hi:[0,1]
    v_pk_add_f32 v[150:151], v[150:151], v[116:117] op_sel_hi:[1,0] neg_lo:[0,1] neg_hi:[0,1]
    v_pk_add_f32 v[152:153], v[152:153], v[116:117] op_sel_hi:[1,0] neg_lo:[0,1] neg_hi:[0,1]
    v_pk_add_f32 v[154:155], v[154:155], v[116:117] op_sel_hi:[1,0] neg_lo:[0,1] neg_hi:[0,1]
    v_pk_add_f32 v[156:157], v[156:157], v[116:117] op_sel_hi:[1,0] neg_lo:[0,1] neg_hi:[0,1]
    v_pk_add_f32 v[158:159], v[158:159], v[116:117] op_sel_hi:[1,0] neg_lo:[0,1] neg_hi:[0,1]
    v_pk_add_f32 v[160:161], v[160:161], v[116:117] op_sel_hi:[1,0] neg_lo:[0,1] neg_hi:[0,1]
    v_pk_add_f32 v[162:163], v[162:163], v[116:117] op_sel_hi:[1,0] neg_lo:[0,1] neg_hi:[0,1]
    v_pk_add_f32 v[164:165], v[164:165], v[116:117] op_sel_hi:[1,0] neg_lo:[0,1] neg_hi:[0,1]
    v_pk_add_f32 v[166:167], v[166:167], v[116:117] op_sel_hi:[1,0] neg_lo:[0,1] neg_hi:[0,1]
    v_pk_mul_f32 v[128:129], v[128:129], v[118:119] op_sel_hi:[1,0]
    v_pk_mul_f32 v[130:131], v[130:131], v[118:119] op_sel_hi:[1,0]
    v_pk_mul_f32 v[132:133], v[132:133], v[118:119] op_sel_hi:[1,0]
    v_pk_mul_f32 v[134:135], v[134:135], v[118:119] op_sel_hi:[1,0]
    v_pk_mul_f32 v[136:137], v[136:137], v[118:119] op_sel_hi:[1,0]
    v_pk_mul_f32 v[138:139], v[138:139], v[118:119] op_sel_hi:[1,0]
    v_pk_mul_f32 v[140:141], v[140:141], v[118:119] op_sel_hi:[1,0]
    v_pk_mul_f32 v[142:143], v[142:143], v[118:119] op_sel_hi:[1,0]
    v_pk_mul_f32 v[144:145], v[144:145], v[118:119] op_sel_hi:[1,0]
    v_pk_mul_f32 v[146:147], v[146:147], v[118:119] op_sel_hi:[1,0]
    v_pk_mul_f32 v[148:149], v[148:149], v[118:119] op_sel_hi:[1,0]
    v_pk_mul_f32 v[150:151], v[150:151], v[118:119] op_sel_hi:[1,0]
    v_pk_mul_f32 v[152:153], v[152:153], v[118:119] op_sel_hi:[1,0]
    v_pk_mul_f32 v[154:155], v[154:155], v[118:119] op_sel_hi:[1,0]
    v_pk_mul_f32 v[156:157], v[156:157], v[118:119] op_sel_hi:[1,0]
    v_pk_mul_f32 v[158:159], v[158:159], v[118:119] op_sel_hi:[1,0]
    v_pk_mul_f32 v[160:161], v[160:161], v[118:119] op_sel_hi:[1,0]
    v_pk_mul_f32 v[162:163], v[162:163], v[118:119] op_sel_hi:[1,0]
    v_pk_mul_f32 v[164:165], v[164:165], v[118:119] op_sel_hi:[1,0]
    v_pk_mul_f32 v[166:167], v[166:167], v[118:119] op_sel_hi:[1,0]
    v_cvt_pk_bf16_f32 v28, v128, v129
    v_cvt_pk_bf16_f32 v29, v130, v131
    v_cvt_pk_bf16_f32 v30, v132, v133
    v_cvt_pk_bf16_f32 v31, v134, v135
    v_cvt_pk_bf16_f32 v32, v136, v137
    v_cvt_pk_bf16_f32 v33, v138, v139
    v_cvt_pk_bf16_f32 v34, v140, v141
    v_cvt_pk_bf16_f32 v35, v142, v143
    v_cvt_pk_bf16_f32 v36, v144, v145
    v_cvt_pk_bf16_f32 v37, v146, v147
    v_cvt_pk_bf16_f32 v38, v148, v149
    v_cvt_pk_bf16_f32 v39, v150, v151
    v_cvt_pk_bf16_f32 v40, v152, v153
    v_cvt_pk_bf16_f32 v41, v154, v155
    v_cvt_pk_bf16_f32 v42, v156, v157
    v_cvt_pk_bf16_f32 v43, v158, v159
    v_cvt_pk_bf16_f32 v44, v160, v161
    v_cvt_pk_bf16_f32 v45, v162, v163
    v_cvt_pk_bf16_f32 v46, v164, v165
    v_cvt_pk_bf16_f32 v47, v166, v167
    ds_write_b128 v7, v[28:31] offset:5184
    ds_write_b128 v7, v[32:35] offset:5440
    ds_write_b128 v7, v[36:39] offset:5696
    ds_write_b128 v7, v[40:43] offset:5952
    ds_write_b128 v7, v[44:47] offset:6208
    v_mov_b32 v9, 163712
    s_cmp_lg_u32 s32, 4
    s_cbranch_scc1 m_hepdone
    ds_write_b32 v9, v111
m_hepdone:
    s_waitcnt lgkmcnt(0)
    s_barrier
    v_bfe_u32 v4, v1, 2, 2
    v_lshl_add_u32 v4, v3, 3, v4
    v_mul_u32_u24 v4, 1296, v4
    v_and_b32 v5, 3, v1
    v_lshl_add_u32 v4, v5, 3, v4
    s_lshl_b32 s43, s32, 5
    v_add_u32 v4, s43, v4
    v_add_u32 v5, 41472, v4
    ds_read_b64_tr_b16 v[16:17], v4 offset:0
    ds_read_b64_tr_b16 v[18:19], v4 offset:5184
    ds_read_b64_tr_b16 v[20:21], v5 offset:0
    ds_read_b64_tr_b16 v[22:23], v5 offset:5184
    ds_read_b64_tr_b16 v[24:25], v4 offset:256
    ds_read_b64_tr_b16 v[26:27], v4 offset:5440
    ds_read_b64_tr_b16 v[28:29], v5 offset:256
    ds_read_b64_tr_b16 v[30:31], v5 offset:5440
    ds_read_b64_tr_b16 v[32:33], v4 offset:512
    ds_read_b64_tr_b16 v[34:35], v4 offset:5696
    ds_read_b64_tr_b16 v[36:37], v5 offset:512
    ds_read_b64_tr_b16 v[38:39], v5 offset:5696
    ds_read_b64_tr_b16 v[40:41], v4 offset:768
    ds_read_b64_tr_b16 v[42:43], v4 offset:5952
    ds_read_b64_tr_b16 v[44:45], v5 offset:768
    ds_read_b64_tr_b16 v[46:47], v5 offset:5952
    ds_read_b64_tr_b16 v[48:49], v4 offset:1024
    ds_read_b64_tr_b16 v[50:51], v4 offset:6208
    ds_read_b64_tr_b16 v[52:53], v5 offset:1024
    ds_read_b64_tr_b16 v[54:55], v5 offset:6208
    s_mul_i32 s43, s32, 4608
    s_add_u32 s43, s43, 90112
    v_mul_u32_u24 v5, 144, v2
    v_lshl_add_u32 v5, v3, 4, v5
    v_add_u32 v5, s43, v5
    v_lshrrev_b32 v4, 3, v1
    v_lshlrev_b32 v6, 12, v4
    v_mul_u32_u24 v4, 144, v4
    v_and_b32 v7, 7, v1
    v_lshl_add_u32 v4, v7, 4, v4
    v_add_u32 v4, s43, v4
    v_lshl_add_u32 v6, v7, 4, v6
    s_lshl_b32 s46, s32, 16
    s_lshl_b32 s44, s35, 7
    s_add_u32 s46, s46, s44
    s_add_u32 s47, s46, 32768
    s_waitcnt vmcnt(0) lgkmcnt(0)
    ds_write_b128 v5, v[16:19] offset:0
    ds_write_b128 v5, v[20:23] offset:64
    ds_read_b128 v[56:59], v4 offset:0
    ds_read_b128 v[60:63], v4 offset:1152
    ds_write_b128 v5, v[24:27] offset:2304
    ds_write_b128 v5, v[28:31] offset:2368
    ds_read_b128 v[64:67], v4 offset:2304
    ds_read_b128 v[68:71], v4 offset:3456
    ds_write_b128 v5, v[32:35] offset:0
    ds_write_b128 v5, v[36:39] offset:64
    ds_read_b128 v[72:75], v4 offset:0
    ds_read_b128 v[76:79], v4 offset:1152
    ds_write_b128 v5, v[40:43] offset:2304
    ds_write_b128 v5, v[44:47] offset:2368
    ds_read_b128 v[80:83], v4 offset:2304
    ds_read_b128 v[84:87], v4 offset:3456
    ds_write_b128 v5, v[48:51] offset:0
    ds_write_b128 v5, v[52:55] offset:64
    ds_read_b128 v[88:91], v4 offset:0
    ds_read_b128 v[92:95], v4 offset:1152
    s_waitcnt lgkmcnt(15)
    buffer_store_dwordx4 v[56:59], v6, s[28:31], s46 offen sc1
    buffer_store_dwordx4 v[60:63], v6, s[28:31], s47 offen sc1
    s_add_u32 s46, s46, 524288
    s_add_u32 s47, s47, 524288
    s_waitcnt lgkmcnt(12)
    buffer_store_dwordx4 v[64:67], v6, s[28:31], s46 offen sc1
    buffer_store_dwordx4 v[68:71], v6, s[28:31], s47 offen sc1
    s_add_u32 s46, s46, 524288
    s_add_u32 s47, s47, 524288
    s_waitcnt lgkmcnt(8)
    buffer_store_dwordx4 v[72:75], v6, s[28:31], s46 offen sc1
    buffer_store_dwordx4 v[76:79], v6, s[28:31], s47 offen sc1
    s_add_u32 s46, s46, 524288
    s_add_u32 s47, s47, 524288
    s_waitcnt lgkmcnt(4)
    buffer_store_dwordx4 v[80:83], v6, s[28:31], s46 offen sc1
    buffer_store_dwordx4 v[84:87], v6, s[28:31], s47 offen sc1
    s_add_u32 s46, s46, 524288
    s_add_u32 s47, s47, 524288
    s_waitcnt lgkmcnt(0)
    buffer_store_dwordx4 v[88:91], v6, s[28:31], s46 offen sc1
    buffer_store_dwordx4 v[92:95], v6, s[28:31], s47 offen sc1
    s_add_u32 s46, s46, 524288
    s_add_u32 s47, s47, 524288
    s_mov_b32 s34, 1000
    s_waitcnt vmcnt(0) lgkmcnt(0)
    s_barrier
    s_cmp_lg_u32 s32, 4
    s_cbranch_scc1 m_hnpx
    s_lshl_b32 s45, s35, 2
    s_add_u32 s45, s45, 4096
    v_mov_b32 v7, 0
    v_mov_b32 v8, s3
    s_waitcnt vmcnt(0)
    s_mov_b64 exec, 1
    buffer_store_dword v8, v7, s[60:63], s45 offen offset:0 sc1
    s_mov_b64 exec, -1
m_hnpx:
    s_cmp_lt_u32 s32, 4
    s_cbranch_scc1 m_Lpost
    v_mov_b32 v4, 163724
    v_mov_b32 v5, 4
    ds_write_b32 v4, v5
    s_branch m_P2
m_end:
    s_endpgm
text_end:
.section .rodata,"a"
.p2align 6
.amdhsa_kernel parallel_sum__ssm_conv_s4d__mixer_gmlp__prompt_kernel
  .amdhsa_next_free_vgpr 256
  .amdhsa_next_free_sgpr 100
  .amdhsa_accum_offset 256
  .amdhsa_group_segment_fixed_size 0
  .amdhsa_kernarg_size 120
  .amdhsa_user_sgpr_count 2
  .amdhsa_user_sgpr_kernarg_segment_ptr 1
  .amdhsa_system_sgpr_workgroup_id_x 1
  .amdhsa_float_denorm_mode_32 3
.end_amdhsa_kernel
```
